```python
import torch

def _softmax(x, axis=-1):
    return torch.softmax(x, dim=axis)
def _gelu(x):
    return torch.nn.functional.gelu(x, approximate="tanh")
def _silu(x):
    return torch.nn.functional.silu(x)
def _sigmoid(x):
    return torch.sigmoid(x)
def _layernorm(x, axis=-1, eps=1e-5):
    m = x.mean(dim=axis, keepdim=True)
    v = x.var(dim=axis, keepdim=True, unbiased=False)
    return (x - m) / torch.sqrt(v + eps)
def _scatter_add(tgt, idx, src, axis=0):
    return tgt.clone().index_add_(axis, idx, src)
def _segment_sum(src, seg, n):
    out = torch.zeros((n,) + src.shape[1:], dtype=src.dtype)
    return out.index_add_(0, seg, src)
def _pad(x, pw):
    flat = tuple(v for pair in reversed(pw) for v in pair)
    return torch.nn.functional.pad(x, flat)

kernel_name = 'interleave_layers__linear_kernel_hedgehog__sliding_block__prompt'

def setup_inputs():

    _w = (lambda a: (lambda t: t.to(torch.bfloat16) if t.is_floating_point() else t)(torch.as_tensor(a)))
    def _A_setup():
        B, S, D, H = 1, 2048, 576, 32
        Dh = D // H
        return {
            "x": _w((lambda *s: torch.randn(*s, dtype=torch.bfloat16) * 0.05)(B, S, D)),
            "wqkv": _w((lambda *s: torch.randn(*s, dtype=torch.bfloat16) * 0.2)(D, 3 * D)),
            "w_phi": _w((lambda *s: torch.randn(*s, dtype=torch.bfloat16) * 0.2)(H, Dh, Dh) * (Dh ** -0.5)),
            "wo": _w((lambda *s: torch.randn(*s, dtype=torch.bfloat16) * 0.05)(D, D)),
        }
    _A_in = _A_setup()

    def _B_setup():
        B, S, D = 1, 2048, 576
        return {
            "x": _w((lambda *s: torch.randn(*s, dtype=torch.bfloat16) * 0.05)(B, S, D)),
            "wqkv": _w((lambda *s: torch.randn(*s, dtype=torch.bfloat16) * 0.1)(D, 3 * D)),
            "wo": _w((lambda *s: torch.randn(*s, dtype=torch.bfloat16) * 0.05)(D, D)),
        }
    _B_in = _B_setup()

    return {
        "A_x": _A_in["x"],
        "A_wqkv": _A_in["wqkv"],
        "A_w_phi": _A_in["w_phi"],
        "A_wo": _A_in["wo"],
        "B_x": _B_in["x"],
        "B_wqkv": _B_in["wqkv"],
        "B_wo": _B_in["wo"],
    }

def reference(A_x, A_wqkv, A_w_phi, A_wo, B_x, B_wqkv, B_wo):
    def _A_ref(x, wqkv, w_phi, wo):
        B, S, D = x.shape
        H = 32; Dh = D // H
        qkv = (lambda x, *d: x.permute(*d))((x @ wqkv).reshape(B, S, 3, H, Dh), 2, 0, 3, 1, 4)
        q, k, v = qkv[0], qkv[1], qkv[2]
        pq = torch.einsum("bhsd,hdf->bhsf", q, w_phi)
        pk = torch.einsum("bhsd,hdf->bhsf", k, w_phi)
        phi_q = torch.concatenate([_softmax(pq, axis=-1), _softmax(-pq, axis=-1)], axis=-1)
        phi_k = torch.concatenate([_softmax(pk, axis=-1), _softmax(-pk, axis=-1)], axis=-1)
        kv = torch.einsum("bhsf,bhsd->bhfd", phi_k, v)
        z  = torch.einsum("bhsf->bhf", phi_k)
        num = torch.einsum("bhqf,bhfd->bhqd", phi_q, kv)
        den = torch.einsum("bhqf,bhf->bhq", phi_q, z)[..., None] + 1e-6
        o = num / den
        return (lambda x, *d: x.permute(*d))(o, 0, 2, 1, 3).reshape(B, S, D) @ wo

    def _B_ref(x, wqkv, wo):
        B, S, D = x.shape
        H = 32; Dh = D // H; W = 256
        qkv = (lambda x, *d: x.permute(*d))((x @ wqkv).reshape(B, S, 3, H, Dh), 2, 0, 3, 1, 4)
        q, k, v = qkv[0], qkv[1], qkv[2]
        scores = torch.einsum("bhqd,bhkd->bhqk", q, k) * (Dh ** -0.5)
        idx = torch.arange(S)
        mask = (idx[:, None] - idx[None, :] >= 0) & (idx[:, None] - idx[None, :] < W)
        scores = torch.where(mask[None, None], scores, -1e9)
        p = _softmax(scores, axis=-1)
        o = torch.einsum("bhqk,bhkd->bhqd", p, v)
        return (lambda x, *d: x.permute(*d))(o, 0, 2, 1, 3).reshape(B, S, D) @ wo

    x = A_x
    x = x + _A_ref(_layernorm(x, axis=-1), A_wqkv, A_w_phi, A_wo)
    x = x + _B_ref(_layernorm(x, axis=-1), B_wqkv, B_wo)
    x = x + _A_ref(_layernorm(x, axis=-1), A_wqkv, A_w_phi, A_wo)
    x = x + _B_ref(_layernorm(x, axis=-1), B_wqkv, B_wo)
    return x
```

```asm
; @launch kernel=prep_kernel grid=(460,1,1) block=(192,1,1) lds=28416
; @launch kernel=mega_kernel grid=(256,1,1) block=(512,1,1) lds=163840
.amdgcn_target "amdgcn-amd-amdhsa--gfx950"
.text
.p2align 8
.globl prep_kernel
.type prep_kernel,@function
prep_kernel:
    s_cmp_ge_u32 s2, 460
    s_cbranch_scc1 prep_end
    s_load_dwordx16 s[4:19], s[0:1], 0
    s_load_dwordx4 s[20:23], s[0:1], 64
    v_and_b32 v1, 63, v0
    v_lshrrev_b32 v2, 6, v0
    v_and_b32 v3, 7, v1
    v_readfirstlane_b32 s24, v2
    v_lshrrev_b32 v4, 3, v1
    s_waitcnt lgkmcnt(0)
    s_cmp_ge_u32 s2, 24
    s_cbranch_scc1 prep_nocpf
    s_getpc_b64 s[56:57]
prep_pc:
    s_lshr_b32 s58, s2, 3
    s_mul_i32 s58, s58, 3
    s_add_u32 s58, s58, s24
    s_lshl_b32 s58, s58, 13
    v_lshlrev_b32 v62, 7, v1
    v_add_u32 v62, s58, v62
    v_cmp_gt_u32 vcc, code_end-prep_pc-4, v62
    s_and_saveexec_b64 s[58:59], vcc
    s_cbranch_execz prep_cpf_skip
    global_load_dword v63, v62, s[56:57]
prep_cpf_skip:
    s_mov_b64 exec, -1
prep_nocpf:
    s_cmp_ge_u32 s2, 332
    s_cbranch_scc1 prep_x
    s_cmp_ge_u32 s2, 308
    s_cbranch_scc1 prep_zero
    s_cmp_ge_u32 s2, 296
    s_cbranch_scc1 prep_spec
    s_cmp_ge_u32 s2, 216
    s_cbranch_scc1 prep_phi
    s_cmp_ge_u32 s2, 162
    s_cbranch_scc1 prep_wo
    s_cmp_ge_u32 s2, 81
    s_cselect_b32 s32, s14, s6
    s_cselect_b32 s33, s15, s7
    s_cselect_b32 s25, 0x200000, 0
    s_cselect_b32 s29, 0x8000, 0
    s_cselect_b32 s26, 81, 0
    s_add_u32 s29, s29, 0x600000
    s_mov_b32 s34, 1990656
    s_mov_b32 s35, 0x00020000
    s_add_u32 s36, s22, s25
    s_addc_u32 s37, s23, 0
    s_mov_b32 s38, 0x1f8000
    s_mov_b32 s39, 0x00020000
    s_add_u32 s52, s22, s29
    s_addc_u32 s53, s23, 0
    s_mov_b32 s54, 0x5400
    s_mov_b32 s55, 0x00020000
    s_sub_u32 s26, s2, s26
    s_mul_i32 s27, s26, 43
    s_lshr_b32 s27, s27, 7
    s_mul_i32 s28, s27, 3
    s_sub_u32 s28, s26, s28
    s_mul_i32 s29, s27, 29
    s_lshr_b32 s29, s29, 8
    s_mul_i32 s30, s29, 9
    s_sub_u32 s30, s27, s30
    s_mul_i32 s31, s28, 3
    s_add_u32 s31, s31, s24
    s_mov_b32 s40, 0
    s_mov_b32 s41, 3456
    s_mov_b32 s42, 6912
    s_mov_b32 s43, 10368
    s_mov_b32 s44, 13824
    s_mov_b32 s45, 17280
    s_mov_b32 s46, 20736
    s_mov_b32 s47, 24192
    s_lshl_b32 s30, s30, 6
    v_lshl_add_u32 v5, v3, 3, s30
    s_lshl_b32 s48, s31, 3
    v_add_u32 v6, s48, v4
    v_mul_u32_u24 v7, 27648, v6
    v_lshl_add_u32 v7, v5, 1, v7
    s_mul_i32 s48, s29, 1152
    v_add_u32 v7, s48, v7
    buffer_load_dwordx4 v[16:19], v7, s[32:35], s40 offen
    buffer_load_dwordx4 v[20:23], v7, s[32:35], s41 offen
    buffer_load_dwordx4 v[24:27], v7, s[32:35], s42 offen
    buffer_load_dwordx4 v[28:31], v7, s[32:35], s43 offen
    buffer_load_dwordx4 v[32:35], v7, s[32:35], s44 offen
    buffer_load_dwordx4 v[36:39], v7, s[32:35], s45 offen
    buffer_load_dwordx4 v[40:43], v7, s[32:35], s46 offen
    buffer_load_dwordx4 v[44:47], v7, s[32:35], s47 offen
    v_add_u32 v10, s30, v1
    v_mul_u32_u24 v11, 3641, v10
    v_lshrrev_b32 v11, 16, v11
    v_mul_u32_u24 v12, 18, v11
    v_sub_u32 v12, v10, v12
    v_and_b32 v13, 1, v11
    s_lshl_b32 s48, s29, 11
    s_sub_u32 s48, s48, 2048
    s_cmp_eq_u32 s29, 0
    s_cselect_b32 s48, 92160, s48
    s_mov_b32 s50, 5120
    s_cselect_b32 s50, 2048, s50
    s_lshl_b32 s49, s29, 6
    s_add_u32 s49, s49, 3840
    v_cmp_gt_u32 vcc, 16, v12
    v_lshl_add_u32 v14, v13, 5, s49
    v_lshl_add_u32 v13, v13, 10, s48
    v_lshrrev_b32 v11, 1, v11
    v_cndmask_b32 v13, v14, v13, vcc
    v_mov_b32 v14, 5120
    v_mov_b32 v15, s50
    s_mov_b32 s50, 129024
    v_cndmask_b32 v14, v14, v15, vcc
    v_mul_u32_u24 v11, s50, v11
    v_lshl_add_u32 v13, v12, 4, v13
    v_add_u32 v13, v13, v11
    s_lshl_b32 s62, s31, 1
    v_mad_u32_u24 v48, v14, s62, v13
    v_add_u32 v51, v48, v14
    s_mov_b32 s62, 0
    s_mov_b32 s63, 0
    s_mov_b32 s51, 1
    s_branch prep_tr
prep_wo:
    s_cmp_ge_u32 s2, 189
    s_cselect_b32 s32, s16, s10
    s_cselect_b32 s33, s17, s11
    s_cselect_b32 s25, 0x100000, 0
    s_cselect_b32 s26, 27, 0
    s_add_u32 s25, s25, 0x400000
    s_add_u32 s26, s26, 162
    s_mov_b32 s34, 663552
    s_mov_b32 s35, 0x00020000
    s_add_u32 s36, s22, s25
    s_addc_u32 s37, s23, 0
    s_mov_b32 s38, 0xb4000
    s_mov_b32 s39, 0x00020000
    s_add_u32 s52, s22, 0x600000
    s_addc_u32 s53, s23, 0
    s_mov_b32 s54, 0x5400
    s_mov_b32 s55, 0x00020000
    s_sub_u32 s26, s2, s26
    s_mul_i32 s27, s26, 11
    s_lshr_b32 s27, s27, 5
    s_mul_i32 s28, s27, 3
    s_sub_u32 s28, s26, s28
    s_mul_i32 s31, s28, 3
    s_add_u32 s31, s31, s24
    s_lshl_b32 s48, s31, 3
    v_add_u32 v6, s48, v4
    s_cmp_eq_u32 s31, 8
    s_cbranch_scc1 prep_b_tail
    s_mov_b32 s40, 0
    s_mov_b32 s41, 1152
    s_mov_b32 s42, 2304
    s_mov_b32 s43, 3456
    s_mov_b32 s44, 9216
    s_mov_b32 s45, 10368
    s_mov_b32 s46, 11520
    s_mov_b32 s47, 12672
    v_lshrrev_b32 v7, 1, v6
    v_mul_u32_u24 v7, 18, v7
    v_and_b32 v8, 1, v6
    v_lshl_add_u32 v7, v8, 2, v7
    s_branch prep_b_row
prep_b_tail:
    s_mov_b32 s40, 0
    s_mov_b32 s41, 1152
    s_mov_b32 s42, 20736
    s_mov_b32 s43, 21888
    s_mov_b32 s44, 41472
    s_mov_b32 s45, 42624
    s_mov_b32 s46, 62208
    s_mov_b32 s47, 63360
    v_mul_u32_u24 v7, 72, v4
    v_add_u32 v7, 16, v7
prep_b_row:
    v_mul_u32_u24 v7, 1152, v7
    v_lshl_add_u32 v7, v3, 4, v7
    s_lshl_b32 s30, s27, 7
    v_add_u32 v7, s30, v7
    buffer_load_dwordx4 v[16:19], v7, s[32:35], s40 offen
    buffer_load_dwordx4 v[20:23], v7, s[32:35], s41 offen
    buffer_load_dwordx4 v[24:27], v7, s[32:35], s42 offen
    buffer_load_dwordx4 v[28:31], v7, s[32:35], s43 offen
    buffer_load_dwordx4 v[32:35], v7, s[32:35], s44 offen
    buffer_load_dwordx4 v[36:39], v7, s[32:35], s45 offen
    buffer_load_dwordx4 v[40:43], v7, s[32:35], s46 offen
    buffer_load_dwordx4 v[44:47], v7, s[32:35], s47 offen
    s_lshl_b32 s30, s27, 6
    v_add_u32 v8, s30, v1
    v_mul_u32_u24 v9, 911, v8
    v_lshrrev_b32 v9, 16, v9
    v_mul_u32_u24 v10, 72, v9
    v_sub_u32 v8, v8, v10
    s_mov_b32 s30, 92160
    v_mul_u32_u24 v9, s30, v9
    v_lshrrev_b32 v10, 4, v8
    v_lshl_add_u32 v9, v10, 10, v9
    v_and_b32 v8, 15, v8
    v_lshl_add_u32 v48, v8, 4, v9
    v_mov_b32 v51, v48
    s_mul_i32 s62, s31, 10240
    s_add_u32 s63, s62, 5120
    s_mov_b32 s51, 0
prep_tr:
    s_mul_i32 s30, s24, 9216
    v_mul_u32_u24 v49, 1152, v4
    v_mul_u32_u24 v50, 144, v3
    v_add3_u32 v49, v49, v50, s30
    v_add_u32 v50, v1, v4
    v_lshlrev_b32 v50, 4, v50
    v_add_u32 v50, s30, v50
    s_mov_b32 s30, 0x05040100
    s_mov_b32 s31, 0x07060302
    s_mov_b32 s26, 0x3f803f80
    s_waitcnt vmcnt(0)
    v_perm_b32 v64, v20, v16, s30
    v_perm_b32 v65, v28, v24, s30
    v_perm_b32 v66, v36, v32, s30
    v_perm_b32 v67, v44, v40, s30
    ds_write_b128 v49, v[64:67] offset:0
    v_perm_b32 v68, v20, v16, s31
    v_perm_b32 v69, v28, v24, s31
    v_perm_b32 v70, v36, v32, s31
    v_perm_b32 v71, v44, v40, s31
    ds_write_b128 v49, v[68:71] offset:16
    v_perm_b32 v72, v21, v17, s30
    v_perm_b32 v73, v29, v25, s30
    v_perm_b32 v74, v37, v33, s30
    v_perm_b32 v75, v45, v41, s30
    ds_write_b128 v49, v[72:75] offset:32
    v_perm_b32 v76, v21, v17, s31
    v_perm_b32 v77, v29, v25, s31
    v_perm_b32 v78, v37, v33, s31
    v_perm_b32 v79, v45, v41, s31
    ds_write_b128 v49, v[76:79] offset:48
    v_perm_b32 v80, v22, v18, s30
    v_perm_b32 v81, v30, v26, s30
    v_perm_b32 v82, v38, v34, s30
    v_perm_b32 v83, v46, v42, s30
    ds_write_b128 v49, v[80:83] offset:64
    v_perm_b32 v84, v22, v18, s31
    v_perm_b32 v85, v30, v26, s31
    v_perm_b32 v86, v38, v34, s31
    v_perm_b32 v87, v46, v42, s31
    ds_write_b128 v49, v[84:87] offset:80
    v_perm_b32 v88, v23, v19, s30
    v_perm_b32 v89, v31, v27, s30
    v_perm_b32 v90, v39, v35, s30
    v_perm_b32 v91, v47, v43, s30
    ds_write_b128 v49, v[88:91] offset:96
    v_perm_b32 v92, v23, v19, s31
    v_perm_b32 v93, v31, v27, s31
    v_perm_b32 v94, v39, v35, s31
    v_perm_b32 v95, v47, v43, s31
    ds_write_b128 v49, v[92:95] offset:112
    s_waitcnt lgkmcnt(0)
    ds_read_b128 v[16:19], v50 offset:0
    ds_read_b128 v[20:23], v50 offset:1152
    ds_read_b128 v[24:27], v50 offset:2304
    ds_read_b128 v[28:31], v50 offset:3456
    ds_read_b128 v[32:35], v50 offset:4608
    ds_read_b128 v[36:39], v50 offset:5760
    ds_read_b128 v[40:43], v50 offset:6912
    ds_read_b128 v[44:47], v50 offset:8064
    s_waitcnt lgkmcnt(7)
    buffer_store_dwordx4 v[16:19], v48, s[36:39], s62 offen offset:0
    s_waitcnt lgkmcnt(6)
    buffer_store_dwordx4 v[20:23], v48, s[36:39], s62 offen offset:256
    s_waitcnt lgkmcnt(5)
    buffer_store_dwordx4 v[24:27], v48, s[36:39], s62 offen offset:512
    s_waitcnt lgkmcnt(4)
    buffer_store_dwordx4 v[28:31], v48, s[36:39], s62 offen offset:768
    s_waitcnt lgkmcnt(3)
    buffer_store_dwordx4 v[32:35], v51, s[36:39], s63 offen offset:0
    s_waitcnt lgkmcnt(2)
    buffer_store_dwordx4 v[36:39], v51, s[36:39], s63 offen offset:256
    s_waitcnt lgkmcnt(1)
    buffer_store_dwordx4 v[40:43], v51, s[36:39], s63 offen offset:512
    s_waitcnt lgkmcnt(0)
    buffer_store_dwordx4 v[44:47], v51, s[36:39], s63 offen offset:768
    s_cmp_eq_u32 s51, 0
    s_cbranch_scc1 prep_end
    v_dot2_f32_bf16 v52, v16, s26, 0
    v_dot2_f32_bf16 v53, v17, s26, 0
    v_dot2_f32_bf16 v54, v18, s26, 0
    v_dot2_f32_bf16 v55, v19, s26, 0
    v_dot2_f32_bf16 v52, v20, s26, v52
    v_dot2_f32_bf16 v53, v21, s26, v53
    v_dot2_f32_bf16 v54, v22, s26, v54
    v_dot2_f32_bf16 v55, v23, s26, v55
    v_dot2_f32_bf16 v52, v24, s26, v52
    v_dot2_f32_bf16 v53, v25, s26, v53
    v_dot2_f32_bf16 v54, v26, s26, v54
    v_dot2_f32_bf16 v55, v27, s26, v55
    v_dot2_f32_bf16 v52, v28, s26, v52
    v_dot2_f32_bf16 v53, v29, s26, v53
    v_dot2_f32_bf16 v54, v30, s26, v54
    v_dot2_f32_bf16 v55, v31, s26, v55
    v_dot2_f32_bf16 v52, v32, s26, v52
    v_dot2_f32_bf16 v53, v33, s26, v53
    v_dot2_f32_bf16 v54, v34, s26, v54
    v_dot2_f32_bf16 v55, v35, s26, v55
    v_dot2_f32_bf16 v52, v36, s26, v52
    v_dot2_f32_bf16 v53, v37, s26, v53
    v_dot2_f32_bf16 v54, v38, s26, v54
    v_dot2_f32_bf16 v55, v39, s26, v55
    v_dot2_f32_bf16 v52, v40, s26, v52
    v_dot2_f32_bf16 v53, v41, s26, v53
    v_dot2_f32_bf16 v54, v42, s26, v54
    v_dot2_f32_bf16 v55, v43, s26, v55
    v_dot2_f32_bf16 v52, v44, s26, v52
    v_dot2_f32_bf16 v53, v45, s26, v53
    v_dot2_f32_bf16 v54, v46, s26, v54
    v_dot2_f32_bf16 v55, v47, s26, v55
    v_lshlrev_b32 v10, 2, v0
    s_nop 1
    v_add_f32 v52, v52, v53
    v_add_f32 v54, v54, v55
    v_add_f32 v52, v52, v54
    ds_write_b32 v10, v52 offset:27648
    s_waitcnt lgkmcnt(0)
    s_barrier
    s_cmp_lg_u32 s24, 0
    s_cbranch_scc1 prep_end
    ds_read_b32 v16, v10 offset:27648
    ds_read_b32 v17, v10 offset:27904
    ds_read_b32 v18, v10 offset:28160
    s_mul_i32 s30, s29, 9
    s_sub_u32 s30, s27, s30
    s_lshl_b32 s30, s30, 6
    s_lshl_b32 s48, s29, 9
    s_lshl_b32 s49, s29, 6
    s_add_u32 s49, s49, 1280
    s_mov_b32 s50, 5376
    v_add_u32 v10, s30, v1
    s_mul_i32 s30, s28, 1792
    v_mov_b32 v8, s30
    v_mul_u32_u24 v11, 3641, v10
    v_lshrrev_b32 v11, 16, v11
    v_mul_u32_u24 v12, 18, v11
    v_sub_u32 v12, v10, v12
    v_and_b32 v13, 1, v11
    v_cmp_gt_u32 vcc, 16, v12
    v_lshl_add_u32 v14, v13, 5, s49
    v_lshl_add_u32 v13, v13, 8, s48
    v_lshrrev_b32 v11, 1, v11
    v_cndmask_b32 v13, v14, v13, vcc
    v_mul_u32_u24 v11, s50, v11
    v_lshl_add_u32 v13, v12, 4, v13
    v_add3_u32 v13, v13, v11, v8
    v_lshrrev_b32 v13, 2, v13
    s_waitcnt lgkmcnt(0)
    v_add_f32 v16, v16, v17
    v_add_f32 v16, v16, v18
    buffer_store_dword v16, v13, s[52:55], 0 offen
    s_branch prep_end
prep_phi:
    s_mov_b32 s32, s8
    s_mov_b32 s33, s9
    s_mov_b32 s34, 0x5100
    s_mov_b32 s35, 0x00020000
    s_add_u32 s36, s22, 0x610000
    s_addc_u32 s37, s23, 0
    s_mov_b32 s38, 0x3c000
    s_mov_b32 s39, 0x00020000
    s_sub_u32 s26, s2, 216
    s_mul_i32 s27, s26, 103
    s_lshr_b32 s27, s27, 9
    s_mul_i32 s29, s27, 5
    s_sub_u32 s29, s26, s29
    s_mov_b32 s28, s24
    v_and_b32 v2, 3, v1
    v_bfe_u32 v3, v1, 2, 1
    v_bfe_u32 v4, v1, 3, 1
    v_lshrrev_b32 v5, 4, v1
    v_lshlrev_b32 v6, 15, v3
    v_lshl_or_b32 v6, v6, 16, v6
    v_cmp_eq_u32 s[50:51], 0, v4
    s_lshl_b32 s30, s29, 2
    v_add_u32 v7, s30, v2
    v_lshlrev_b32 v8, 2, v5
    s_cmp_eq_u32 s28, 0
    s_cbranch_scc1 prep_phi_d0
    v_mov_b32 v8, 16
prep_phi_d0:
    s_lshl_b32 s30, s27, 1
    v_add_u32 v9, s30, v4
    v_mul_u32_u24 v9, 324, v9
    v_mul_u32_u24 v8, 18, v8
    v_add3_u32 v9, v9, v8, v7
    v_lshlrev_b32 v9, 1, v9
    v_mov_b32 v10, 0x7fff0000
    v_cmp_gt_u32 vcc, 18, v7
    s_nop 1
    v_cndmask_b32 v9, v10, v9, vcc
    s_cmp_eq_u32 s28, 0
    s_cbranch_scc1 prep_phi_ld
    s_sub_u32 s30, s28, 1
    v_cmp_eq_u32 vcc, s30, v5
    s_nop 1
    v_cndmask_b32 v9, v10, v9, vcc
prep_phi_ld:
    buffer_load_ushort v16, v9, s[32:35], 0 offen offset:0
    buffer_load_ushort v17, v9, s[32:35], 0 offen offset:36
    buffer_load_ushort v18, v9, s[32:35], 0 offen offset:72
    buffer_load_ushort v19, v9, s[32:35], 0 offen offset:108
    s_waitcnt vmcnt(0)
    v_lshl_or_b32 v16, v17, 16, v16
    v_lshl_or_b32 v18, v19, 16, v18
    v_xor_b32 v16, v16, v6
    v_xor_b32 v18, v18, v6
    v_cndmask_b32 v20, 0, v16, s[50:51]
    s_cmp_eq_u32 s28, 0
    s_cbranch_scc0 prep_phi_tb
    v_cndmask_b32 v21, 0, v18, s[50:51]
    v_cndmask_b32 v22, v16, 0, s[50:51]
    v_cndmask_b32 v23, v18, 0, s[50:51]
    s_branch prep_phi_st
prep_phi_tb:
    v_cndmask_b32 v21, v16, 0, s[50:51]
    v_mov_b32 v22, 0
    v_mov_b32 v23, 0
prep_phi_st:
    s_mul_i32 s30, s27, 15
    s_mul_i32 s31, s28, 5
    s_add_u32 s30, s30, s31
    s_add_u32 s30, s30, s29
    s_lshl_b32 s30, s30, 10
    v_lshlrev_b32 v11, 4, v1
    buffer_store_dwordx4 v[20:23], v11, s[36:39], s30 offen
    s_branch prep_end
prep_spec:
    s_sub_u32 s26, s2, 296
    s_cmp_ge_u32 s26, 6
    s_cselect_b32 s25, 0x200000, 0
    s_cselect_b32 s29, 0x8000, 0
    s_cselect_b32 s27, 6, 0
    s_add_u32 s29, s29, 0x600000
    s_add_u32 s36, s22, s25
    s_addc_u32 s37, s23, 0
    s_mov_b32 s38, 0x1f8000
    s_mov_b32 s39, 0x00020000
    s_add_u32 s52, s22, s29
    s_addc_u32 s53, s23, 0
    s_mov_b32 s54, 0x5400
    s_mov_b32 s55, 0x00020000
    s_sub_u32 s26, s26, s27
    s_mul_i32 s26, s26, 192
    v_add_u32 v2, s26, v0
    v_lshrrev_b32 v3, 2, v2
    v_mul_u32_u24 v4, 3641, v3
    v_lshrrev_b32 v4, 16, v4
    v_mul_u32_u24 v6, 18, v4
    v_sub_u32 v6, v3, v6
    s_mov_b32 s28, 129024
    v_mul_u32_u24 v4, s28, v4
    v_mul_u32_u24 v6, 5120, v6
    v_add_u32 v4, v4, v6
    v_and_b32 v5, 3, v2
    v_lshl_add_u32 v4, v5, 8, v4
    v_add_u32 v4, 4288, v4
    v_mov_b32 v8, 0x3f803f80
    v_mov_b32 v12, 0
    v_mov_b32 v9, 0x3f803f80
    v_mov_b32 v13, 0
    v_mov_b32 v10, 0x3f803f80
    v_mov_b32 v14, 0
    v_mov_b32 v11, 0x3f803f80
    v_mov_b32 v15, 0
    buffer_store_dwordx4 v[8:11], v4, s[36:39], 0 offen
    buffer_store_dwordx4 v[12:15], v4, s[36:39], 0 offen offset:16
    buffer_store_dwordx4 v[12:15], v4, s[36:39], 0 offen offset:32
    buffer_store_dwordx4 v[12:15], v4, s[36:39], 0 offen offset:48
    v_mul_u32_u24 v6, 448, v2
    v_add_u32 v6, 432, v6
    buffer_store_dwordx4 v[12:15], v6, s[52:55], 0 offen
    s_branch prep_end
prep_zero:
    s_add_u32 s36, s22, 0x660000
    s_addc_u32 s37, s23, 0
    s_mov_b32 s38, 0x2e000
    s_mov_b32 s39, 0x00020000
    s_sub_u32 s27, s2, 308
    s_mul_i32 s27, s27, 9216
    v_lshlrev_b32 v2, 4, v0
    v_add_u32 v2, s27, v2
    v_mov_b32 v4, 0
    v_mov_b32 v5, 0
    v_mov_b32 v6, 0
    v_mov_b32 v7, 0
    s_mov_b32 s28, 0
    buffer_store_dwordx4 v[4:7], v2, s[36:39], s28 offen
    s_mov_b32 s28, 3072
    buffer_store_dwordx4 v[4:7], v2, s[36:39], s28 offen
    s_mov_b32 s28, 6144
    buffer_store_dwordx4 v[4:7], v2, s[36:39], s28 offen
    s_add_u32 s36, s22, 0x700000
    s_addc_u32 s37, s23, 0
    s_mov_b32 s38, 0x70000
    s_mov_b32 s39, 0x00020000
    s_sub_u32 s27, s2, 308
    s_mul_i32 s27, s27, 21504
    v_lshlrev_b32 v2, 4, v0
    buffer_store_dwordx4 v[4:7], v2, s[36:39], s27 offen
    s_add_u32 s27, s27, 3072
    buffer_store_dwordx4 v[4:7], v2, s[36:39], s27 offen
    s_add_u32 s27, s27, 3072
    buffer_store_dwordx4 v[4:7], v2, s[36:39], s27 offen
    s_add_u32 s27, s27, 3072
    buffer_store_dwordx4 v[4:7], v2, s[36:39], s27 offen
    s_add_u32 s27, s27, 3072
    buffer_store_dwordx4 v[4:7], v2, s[36:39], s27 offen
    s_add_u32 s27, s27, 3072
    buffer_store_dwordx4 v[4:7], v2, s[36:39], s27 offen
    s_add_u32 s27, s27, 3072
    buffer_store_dwordx4 v[4:7], v2, s[36:39], s27 offen
    s_add_u32 s27, s27, 3072
    s_branch prep_end
prep_x:
    s_mov_b32 s32, s4
    s_mov_b32 s33, s5
    s_mov_b32 s34, 0x240000
    s_mov_b32 s35, 0x00020000
    s_add_u32 s36, s22, 0x2400000
    s_addc_u32 s37, s23, 0
    s_mov_b32 s38, 0x240000
    s_mov_b32 s39, 0x00020000
    s_sub_u32 s26, s2, 332
    s_and_b32 s27, s26, 3
    s_lshl_b32 s27, s27, 5
    s_lshr_b32 s26, s26, 2
    s_add_u32 s26, s26, s27
    v_lshrrev_b32 v2, 2, v1
    v_and_b32 v3, 3, v1
    v_mul_u32_u24 v4, 1152, v2
    v_lshl_add_u32 v4, v3, 4, v4
    s_mul_i32 s27, s26, 18432
    s_mul_i32 s28, s24, 384
    s_add_u32 s28, s28, s27
    buffer_load_dwordx4 v[16:19], v4, s[32:35], s28 offen offset:0
    buffer_load_dwordx4 v[20:23], v4, s[32:35], s28 offen offset:64
    buffer_load_dwordx4 v[24:27], v4, s[32:35], s28 offen offset:128
    buffer_load_dwordx4 v[28:31], v4, s[32:35], s28 offen offset:192
    buffer_load_dwordx4 v[32:35], v4, s[32:35], s28 offen offset:256
    buffer_load_dwordx4 v[36:39], v4, s[32:35], s28 offen offset:320
    v_lshlrev_b32 v5, 4, v2
    v_lshl_add_u32 v5, v3, 8, v5
    s_mul_i32 s28, s24, 6144
    v_add_u32 v5, s28, v5
    v_lshlrev_b32 v6, 4, v1
    v_add_u32 v7, s28, v6
    s_add_u32 s28, s28, s27
    s_add_u32 s29, s28, 3072
    s_waitcnt vmcnt(5)
    ds_write_b128 v5, v[16:19] offset:0
    s_waitcnt vmcnt(4)
    ds_write_b128 v5, v[20:23] offset:1024
    s_waitcnt vmcnt(3)
    ds_write_b128 v5, v[24:27] offset:2048
    s_waitcnt vmcnt(2)
    ds_write_b128 v5, v[28:31] offset:3072
    s_waitcnt vmcnt(1)
    ds_write_b128 v5, v[32:35] offset:4096
    s_waitcnt vmcnt(0)
    ds_write_b128 v5, v[36:39] offset:5120
    s_waitcnt lgkmcnt(0)
    ds_read_b128 v[40:43], v7 offset:0
    ds_read_b128 v[44:47], v7 offset:1024
    ds_read_b128 v[48:51], v7 offset:2048
    ds_read_b128 v[52:55], v7 offset:3072
    ds_read_b128 v[56:59], v7 offset:4096
    ds_read_b128 v[60:63], v7 offset:5120
    s_waitcnt lgkmcnt(5)
    buffer_store_dwordx4 v[40:43], v6, s[36:39], s28 offen offset:0
    s_waitcnt lgkmcnt(4)
    buffer_store_dwordx4 v[44:47], v6, s[36:39], s28 offen offset:1024
    s_waitcnt lgkmcnt(3)
    buffer_store_dwordx4 v[48:51], v6, s[36:39], s28 offen offset:2048
    s_waitcnt lgkmcnt(2)
    buffer_store_dwordx4 v[52:55], v6, s[36:39], s29 offen offset:0
    s_waitcnt lgkmcnt(1)
    buffer_store_dwordx4 v[56:59], v6, s[36:39], s29 offen offset:1024
    s_waitcnt lgkmcnt(0)
    buffer_store_dwordx4 v[60:63], v6, s[36:39], s29 offen offset:2048
prep_end:
    s_endpgm
.p2align 8
.globl mega_kernel
.type mega_kernel,@function
mega_kernel:
    s_cmp_ge_u32 s2, 256
    s_cbranch_scc1 mega_end
    s_load_dwordx2 s[18:19], s[0:1], 56
    s_load_dwordx2 s[22:23], s[0:1], 72
    s_and_b32 s24, s2, 3
    s_lshl_b32 s12, s24, 3
    s_lshl_b32 s24, s24, 2
    s_bfe_u32 s25, s2, 0x20003
    s_add_u32 s24, s24, s25
    s_bfe_u32 s11, s2, 0x10002
    s_lshl_b32 s13, s11, 2
    s_add_u32 s13, s13, s25
    s_lshl_b32 s25, s11, 3
    s_lshr_b32 s26, s2, 5
    s_add_u32 s25, s25, s26
    s_add_u32 s12, s12, s26
    s_and_b32 s12, s2, 7
    s_lshl_b32 s12, s12, 2
    s_lshr_b32 s13, s2, 6
    s_add_u32 s12, s12, s13
    s_bfe_u32 s13, s2, 0x30003
    v_lshrrev_b32 v2, 6, v0
    v_and_b32 v1, 63, v0
    v_readfirstlane_b32 s26, v2
    v_lshlrev_b32 v5, 4, v1
    v_mov_b32 v2, 0
    s_mov_b32 s10, 0
    s_mov_b32 s93, 0
    s_and_b32 s27, s26, 3
    s_lshr_b32 s28, s26, 2
    s_waitcnt lgkmcnt(0)
    s_mov_b32 s32, s22
    s_mov_b32 s33, s23
    s_mov_b32 s34, 0x5000000
    s_mov_b32 s35, 0x00020000
    s_mov_b32 s36, s18
    s_mov_b32 s37, s19
    s_mov_b32 s38, 0x240000
    s_mov_b32 s39, 0x00020000
    s_mov_b32 s16, 0
    s_mov_b32 s17, 0
    s_and_b32 s9, s2, 7
    s_lshl_b32 s9, s9, 7
    s_add_u32 s9, s9, 0x708000
    s_lshl_b32 s31, s26, 10
    s_add_u32 s31, s31, 0
    s_add_u32 m0, s31, 34816
    s_mul_i32 s56, s25, 129024
    s_add_u32 s31, s31, s56
    s_mul_i32 s56, s10, 0x200000
    s_add_u32 s31, s31, s56
    buffer_load_dwordx4 v5, s[32:35], s31 offen offset:0  lds
    s_add_u32 m0, m0, 8192
    s_add_u32 s31, s31, 8192
    buffer_load_dwordx4 v5, s[32:35], s31 offen offset:0  lds
    s_add_u32 m0, m0, 8192
    s_add_u32 s31, s31, 8192
    buffer_load_dwordx4 v5, s[32:35], s31 offen offset:0  lds
    s_add_u32 m0, m0, 8192
    s_add_u32 s31, s31, 8192
    buffer_load_dwordx4 v5, s[32:35], s31 offen offset:0  lds
    s_add_u32 m0, m0, 8192
    s_add_u32 s31, s31, 8192
    buffer_load_dwordx4 v5, s[32:35], s31 offen offset:0  lds
    s_add_u32 m0, m0, 8192
    s_add_u32 s31, s31, 8192
    buffer_load_dwordx4 v5, s[32:35], s31 offen offset:0  lds
    s_add_u32 m0, m0, 8192
    s_add_u32 s31, s31, 8192
    buffer_load_dwordx4 v5, s[32:35], s31 offen offset:0  lds
    s_add_u32 m0, m0, 8192
    s_add_u32 s31, s31, 8192
    buffer_load_dwordx4 v5, s[32:35], s31 offen offset:0  lds
    s_add_u32 m0, m0, 8192
    s_add_u32 s31, s31, 8192
    buffer_load_dwordx4 v5, s[32:35], s31 offen offset:0  lds
    s_add_u32 m0, m0, 8192
    s_add_u32 s31, s31, 8192
    buffer_load_dwordx4 v5, s[32:35], s31 offen offset:0  lds
    s_add_u32 m0, m0, 8192
    s_add_u32 s31, s31, 8192
    buffer_load_dwordx4 v5, s[32:35], s31 offen offset:0  lds
    s_add_u32 m0, m0, 8192
    s_add_u32 s31, s31, 8192
    buffer_load_dwordx4 v5, s[32:35], s31 offen offset:0  lds
    s_add_u32 m0, m0, 8192
    s_add_u32 s31, s31, 8192
    buffer_load_dwordx4 v5, s[32:35], s31 offen offset:0  lds
    s_add_u32 m0, m0, 8192
    s_add_u32 s31, s31, 8192
    buffer_load_dwordx4 v5, s[32:35], s31 offen offset:0  lds
    s_add_u32 m0, m0, 8192
    s_add_u32 s31, s31, 8192
    buffer_load_dwordx4 v5, s[32:35], s31 offen offset:0  lds
    s_add_u32 m0, m0, 8192
    s_add_u32 s31, s31, 8192
    s_cmp_ge_u32 s26, 6
    s_cselect_b32 s56, 8192, 0
    s_sub_u32 m0, m0, s56
    s_sub_u32 s31, s31, s56
    buffer_load_dwordx4 v5, s[32:35], s31 offen offset:0  lds
    s_waitcnt vmcnt(0)
    s_barrier
L_top:
    s_and_b32 s14, s10, 1
    s_lshl_b32 s31, s26, 11
    s_add_u32 m0, s31, 0
    s_mul_i32 s56, s25, 15360
    s_add_u32 s31, s31, s56
    s_add_u32 s31, s31, 0x610000
    s_cmp_eq_u32 s14, 1
    s_cbranch_scc1 q_noTd
    buffer_load_dwordx4 v5, s[32:35], s31 offen offset:0  lds
    s_cmp_eq_u32 s26, 7
    s_cbranch_scc1 q_noTd
    buffer_load_dwordx4 v5, s[32:35], s31 offen offset:1024  lds
q_noTd:
    s_mul_i32 s56, s25, 1344
    s_mul_i32 s57, s14, 0x8000
    s_add_u32 s56, s56, s57
    s_add_u32 s56, s56, 0x600000
    buffer_load_dwordx4 v[224:227], v5, s[32:35], s56 offen offset:0
    buffer_load_dwordx4 v[228:231], v5, s[32:35], s56 offen offset:448
    buffer_load_dwordx4 v[232:235], v5, s[32:35], s56 offen offset:896
    v_and_b32 v3, 15, v1
    v_lshrrev_b32 v4, 4, v1
    s_lshl_b32 s29, s24, 7
    s_lshl_b32 s30, s27, 5
    s_add_u32 s29, s29, s30
    s_lshl_b32 s30, s28, 4
    s_add_u32 s29, s29, s30
    v_add_u32 v6, s29, v3
    s_lshr_b32 s30, s29, 4
    s_xor_b32 s69, s30, 1
    s_mul_i32 s30, s30, 18432
    s_mul_i32 s69, s69, 18432
    s_mul_i32 s31, s28, 9216
    s_mul_i32 s56, s10, 0x240000
    s_add_u32 s31, s31, s56
    s_add_u32 s31, s31, 0x2400000
    s_add_u32 s30, s30, s31
    s_add_u32 s69, s69, s31
    s_mul_i32 s56, s28, 46080
    s_add_u32 s56, s56, 34816
    v_add_u32 v10, s56, v5
    s_mul_i32 s57, s27, 6144
    v_add_u32 v14, s57, v10
    s_xor_b32 s56, s28, 1
    s_mul_i32 s56, s56, 46080
    s_add_u32 s56, s56, s57
    s_add_u32 s56, s56, 34816
    v_add_u32 v15, s56, v5
    s_mul_i32 s56, s28, 18432
    s_add_u32 s56, s56, 126976
    v_add_u32 v7, s56, v5
    v_and_b32 v11, 3, v3
    v_cmp_eq_u32 s[58:59], 1, v11
    v_cmp_eq_u32 s[60:61], 2, v11
    v_cmp_eq_u32 s[62:63], 3, v11
    v_lshrrev_b32 v11, 2, v3
    v_lshl_add_u32 v11, v11, 4, v3
    v_lshlrev_b32 v11, 2, v11
    v_lshlrev_b32 v24, 2, v3
    v_add_u32 v24, 192, v24
    v_lshlrev_b32 v25, 4, v4
    v_add_u32 v25, 16384, v25
    v_add_u32 v26, 16384, v5
    s_lshl_b32 s56, s10, 4
    s_add_u32 s56, s56, s24
    s_lshl_b32 s56, s56, 4
    s_add_u32 s56, s56, s25
    s_lshl_b32 s56, s56, 7
    s_add_u32 s56, s56, 0x6f8000
    s_waitcnt vmcnt(0)
    v_pk_add_f32 v[224:225], v[224:225], v[228:229]
    v_pk_add_f32 v[226:227], v[226:227], v[230:231]
    v_pk_add_f32 v[224:225], v[224:225], v[232:233]
    v_pk_add_f32 v[226:227], v[226:227], v[234:235]
    s_cmp_lg_u32 s26, 1
    s_cbranch_scc1 q_nocs
    s_mov_b64 exec, 0xfffffff
    ds_write_b128 v26, v[224:227]
    v_mov_b32 v27, 33792
    v_mov_b32 v28, 0
    s_mov_b64 exec, 1
    ds_write_b32 v27, v28
    s_mov_b64 exec, -1
q_nocs:
    s_cmp_lg_u32 s26, 0
    s_cbranch_scc1 pl1_e
    s_cmp_eq_u32 s10, 0
    s_cbranch_scc1 pl1_e
    v_mov_b32 v29, 0
    s_mov_b64 exec, 1
    s_mov_b32 s90, 0
pl1:
    buffer_load_dword v27, v29, s[32:35], s56 offen sc1
    s_waitcnt vmcnt(0)
    v_readfirstlane_b32 s91, v27
    s_add_u32 s90, s90, 1
    s_cmp_ge_u32 s90, 200000
    s_cbranch_scc1 pl1_d
    s_cmp_lt_u32 s91, 16
    s_cbranch_scc1 pl1
pl1_d:
    s_mov_b64 exec, -1
pl1_e:
    s_waitcnt lgkmcnt(0)
    s_barrier
    buffer_load_dwordx4 v[32:35], v5, s[32:35], s30 offen offset:0
    buffer_load_dwordx4 v[68:71], v5, s[32:35], s69 offen offset:0
    buffer_load_dwordx4 v[36:39], v5, s[32:35], s30 offen offset:1024
    buffer_load_dwordx4 v[72:75], v5, s[32:35], s69 offen offset:1024
    buffer_load_dwordx4 v[40:43], v5, s[32:35], s30 offen offset:2048
    buffer_load_dwordx4 v[76:79], v5, s[32:35], s69 offen offset:2048
    ds_read_b128 v[152:155], v10 offset:0
    ds_read_b128 v[156:159], v10 offset:1024
    ds_read_b128 v[160:163], v10 offset:2048
    ds_read_b128 v[164:167], v10 offset:3072
    ds_read_b128 v[168:171], v10 offset:4096
    s_waitcnt vmcnt(4) lgkmcnt(0)
    v_mfma_f32_16x16x32_bf16 v[124:127], v[32:35], v[32:35], 0
    ds_read_b128 v[172:175], v10 offset:5120
    v_mfma_f32_16x16x32_bf16 v[148:151], v[68:71], v[68:71], 0
    ds_read_b128 v[176:179], v10 offset:6144
    v_mfma_f32_16x16x32_bf16 v[104:107], v[152:155], v[32:35], 0
    ds_read_b128 v[180:183], v10 offset:7168
    v_mfma_f32_16x16x32_bf16 v[128:131], v[152:155], v[68:71], 0
    ds_read_b128 v[184:187], v10 offset:8192
    v_mfma_f32_16x16x32_bf16 v[108:111], v[156:159], v[32:35], 0
    ds_read_b128 v[188:191], v10 offset:9216
    v_mfma_f32_16x16x32_bf16 v[132:135], v[156:159], v[68:71], 0
    buffer_load_dwordx4 v[44:47], v5, s[32:35], s30 offen offset:3072
    v_mfma_f32_16x16x32_bf16 v[112:115], v[160:163], v[32:35], 0
    v_mfma_f32_16x16x32_bf16 v[136:139], v[160:163], v[68:71], 0
    v_mfma_f32_16x16x32_bf16 v[116:119], v[164:167], v[32:35], 0
    buffer_load_dwordx4 v[80:83], v5, s[32:35], s69 offen offset:3072
    v_mfma_f32_16x16x32_bf16 v[140:143], v[164:167], v[68:71], 0
    v_mfma_f32_16x16x32_bf16 v[120:123], v[168:171], v[32:35], 0
    v_mfma_f32_16x16x32_bf16 v[144:147], v[168:171], v[68:71], 0
    s_waitcnt vmcnt(4) lgkmcnt(0)
    v_mfma_f32_16x16x32_bf16 v[124:127], v[36:39], v[36:39], v[124:127]
    ds_read_b128 v[152:155], v10 offset:10240
    v_mfma_f32_16x16x32_bf16 v[148:151], v[72:75], v[72:75], v[148:151]
    ds_read_b128 v[156:159], v10 offset:11264
    v_mfma_f32_16x16x32_bf16 v[104:107], v[172:175], v[36:39], v[104:107]
    ds_read_b128 v[160:163], v10 offset:12288
    v_mfma_f32_16x16x32_bf16 v[128:131], v[172:175], v[72:75], v[128:131]
    ds_read_b128 v[164:167], v10 offset:13312
    v_mfma_f32_16x16x32_bf16 v[108:111], v[176:179], v[36:39], v[108:111]
    ds_read_b128 v[168:171], v10 offset:14336
    v_mfma_f32_16x16x32_bf16 v[132:135], v[176:179], v[72:75], v[132:135]
    s_add_u32 s30, s30, 4096
    s_add_u32 s69, s69, 4096
    buffer_load_dwordx4 v[48:51], v5, s[32:35], s30 offen offset:0
    v_mfma_f32_16x16x32_bf16 v[112:115], v[180:183], v[36:39], v[112:115]
    v_mfma_f32_16x16x32_bf16 v[136:139], v[180:183], v[72:75], v[136:139]
    v_mfma_f32_16x16x32_bf16 v[116:119], v[184:187], v[36:39], v[116:119]
    buffer_load_dwordx4 v[84:87], v5, s[32:35], s69 offen offset:0
    v_mfma_f32_16x16x32_bf16 v[140:143], v[184:187], v[72:75], v[140:143]
    v_mfma_f32_16x16x32_bf16 v[120:123], v[188:191], v[36:39], v[120:123]
    v_mfma_f32_16x16x32_bf16 v[144:147], v[188:191], v[72:75], v[144:147]
    s_waitcnt vmcnt(4) lgkmcnt(0)
    v_mfma_f32_16x16x32_bf16 v[124:127], v[40:43], v[40:43], v[124:127]
    ds_read_b128 v[172:175], v10 offset:15360
    v_mfma_f32_16x16x32_bf16 v[148:151], v[76:79], v[76:79], v[148:151]
    ds_read_b128 v[176:179], v10 offset:16384
    v_mfma_f32_16x16x32_bf16 v[104:107], v[152:155], v[40:43], v[104:107]
    ds_read_b128 v[180:183], v10 offset:17408
    v_mfma_f32_16x16x32_bf16 v[128:131], v[152:155], v[76:79], v[128:131]
    ds_read_b128 v[184:187], v10 offset:18432
    v_mfma_f32_16x16x32_bf16 v[108:111], v[156:159], v[40:43], v[108:111]
    ds_read_b128 v[188:191], v10 offset:19456
    v_mfma_f32_16x16x32_bf16 v[132:135], v[156:159], v[76:79], v[132:135]
    buffer_load_dwordx4 v[52:55], v5, s[32:35], s30 offen offset:1024
    v_mfma_f32_16x16x32_bf16 v[112:115], v[160:163], v[40:43], v[112:115]
    v_mfma_f32_16x16x32_bf16 v[136:139], v[160:163], v[76:79], v[136:139]
    v_mfma_f32_16x16x32_bf16 v[116:119], v[164:167], v[40:43], v[116:119]
    buffer_load_dwordx4 v[88:91], v5, s[32:35], s69 offen offset:1024
    v_mfma_f32_16x16x32_bf16 v[140:143], v[164:167], v[76:79], v[140:143]
    v_mfma_f32_16x16x32_bf16 v[120:123], v[168:171], v[40:43], v[120:123]
    v_mfma_f32_16x16x32_bf16 v[144:147], v[168:171], v[76:79], v[144:147]
    s_waitcnt vmcnt(4) lgkmcnt(0)
    v_mfma_f32_16x16x32_bf16 v[124:127], v[44:47], v[44:47], v[124:127]
    ds_read_b128 v[152:155], v10 offset:20480
    v_mfma_f32_16x16x32_bf16 v[148:151], v[80:83], v[80:83], v[148:151]
    ds_read_b128 v[156:159], v10 offset:21504
    v_mfma_f32_16x16x32_bf16 v[104:107], v[172:175], v[44:47], v[104:107]
    ds_read_b128 v[160:163], v10 offset:22528
    v_mfma_f32_16x16x32_bf16 v[128:131], v[172:175], v[80:83], v[128:131]
    ds_read_b128 v[164:167], v10 offset:23552
    v_mfma_f32_16x16x32_bf16 v[108:111], v[176:179], v[44:47], v[108:111]
    ds_read_b128 v[168:171], v10 offset:24576
    v_mfma_f32_16x16x32_bf16 v[132:135], v[176:179], v[80:83], v[132:135]
    buffer_load_dwordx4 v[56:59], v5, s[32:35], s30 offen offset:2048
    v_mfma_f32_16x16x32_bf16 v[112:115], v[180:183], v[44:47], v[112:115]
    v_mfma_f32_16x16x32_bf16 v[136:139], v[180:183], v[80:83], v[136:139]
    v_mfma_f32_16x16x32_bf16 v[116:119], v[184:187], v[44:47], v[116:119]
    buffer_load_dwordx4 v[92:95], v5, s[32:35], s69 offen offset:2048
    v_mfma_f32_16x16x32_bf16 v[140:143], v[184:187], v[80:83], v[140:143]
    v_mfma_f32_16x16x32_bf16 v[120:123], v[188:191], v[44:47], v[120:123]
    v_mfma_f32_16x16x32_bf16 v[144:147], v[188:191], v[80:83], v[144:147]
    s_waitcnt vmcnt(4) lgkmcnt(0)
    v_mfma_f32_16x16x32_bf16 v[124:127], v[48:51], v[48:51], v[124:127]
    ds_read_b128 v[172:175], v10 offset:25600
    v_mfma_f32_16x16x32_bf16 v[148:151], v[84:87], v[84:87], v[148:151]
    ds_read_b128 v[176:179], v10 offset:26624
    v_mfma_f32_16x16x32_bf16 v[104:107], v[152:155], v[48:51], v[104:107]
    ds_read_b128 v[180:183], v10 offset:27648
    v_mfma_f32_16x16x32_bf16 v[128:131], v[152:155], v[84:87], v[128:131]
    ds_read_b128 v[184:187], v10 offset:28672
    v_mfma_f32_16x16x32_bf16 v[108:111], v[156:159], v[48:51], v[108:111]
    ds_read_b128 v[188:191], v10 offset:29696
    v_mfma_f32_16x16x32_bf16 v[132:135], v[156:159], v[84:87], v[132:135]
    buffer_load_dwordx4 v[60:63], v5, s[32:35], s30 offen offset:3072
    v_mfma_f32_16x16x32_bf16 v[112:115], v[160:163], v[48:51], v[112:115]
    v_mfma_f32_16x16x32_bf16 v[136:139], v[160:163], v[84:87], v[136:139]
    v_mfma_f32_16x16x32_bf16 v[116:119], v[164:167], v[48:51], v[116:119]
    buffer_load_dwordx4 v[96:99], v5, s[32:35], s69 offen offset:3072
    v_mfma_f32_16x16x32_bf16 v[140:143], v[164:167], v[84:87], v[140:143]
    v_mfma_f32_16x16x32_bf16 v[120:123], v[168:171], v[48:51], v[120:123]
    v_mfma_f32_16x16x32_bf16 v[144:147], v[168:171], v[84:87], v[144:147]
    s_waitcnt vmcnt(4) lgkmcnt(0)
    v_mfma_f32_16x16x32_bf16 v[124:127], v[52:55], v[52:55], v[124:127]
    ds_read_b128 v[152:155], v10 offset:30720
    v_mfma_f32_16x16x32_bf16 v[148:151], v[88:91], v[88:91], v[148:151]
    ds_read_b128 v[156:159], v10 offset:31744
    v_mfma_f32_16x16x32_bf16 v[104:107], v[172:175], v[52:55], v[104:107]
    ds_read_b128 v[160:163], v10 offset:32768
    v_mfma_f32_16x16x32_bf16 v[128:131], v[172:175], v[88:91], v[128:131]
    ds_read_b128 v[164:167], v10 offset:33792
    v_mfma_f32_16x16x32_bf16 v[108:111], v[176:179], v[52:55], v[108:111]
    ds_read_b128 v[168:171], v10 offset:34816
    v_mfma_f32_16x16x32_bf16 v[132:135], v[176:179], v[88:91], v[132:135]
    s_add_u32 s30, s30, 4096
    s_add_u32 s69, s69, 4096
    buffer_load_dwordx4 v[64:67], v5, s[32:35], s30 offen offset:0
    v_mfma_f32_16x16x32_bf16 v[112:115], v[180:183], v[52:55], v[112:115]
    v_mfma_f32_16x16x32_bf16 v[136:139], v[180:183], v[88:91], v[136:139]
    v_mfma_f32_16x16x32_bf16 v[116:119], v[184:187], v[52:55], v[116:119]
    buffer_load_dwordx4 v[100:103], v5, s[32:35], s69 offen offset:0
    v_mfma_f32_16x16x32_bf16 v[140:143], v[184:187], v[88:91], v[140:143]
    v_mfma_f32_16x16x32_bf16 v[120:123], v[188:191], v[52:55], v[120:123]
    v_mfma_f32_16x16x32_bf16 v[144:147], v[188:191], v[88:91], v[144:147]
    s_waitcnt vmcnt(4) lgkmcnt(0)
    v_mfma_f32_16x16x32_bf16 v[124:127], v[56:59], v[56:59], v[124:127]
    ds_read_b128 v[172:175], v10 offset:35840
    v_mfma_f32_16x16x32_bf16 v[148:151], v[92:95], v[92:95], v[148:151]
    ds_read_b128 v[176:179], v10 offset:36864
    v_mfma_f32_16x16x32_bf16 v[104:107], v[152:155], v[56:59], v[104:107]
    ds_read_b128 v[180:183], v10 offset:37888
    v_mfma_f32_16x16x32_bf16 v[128:131], v[152:155], v[92:95], v[128:131]
    ds_read_b128 v[184:187], v10 offset:38912
    v_mfma_f32_16x16x32_bf16 v[108:111], v[156:159], v[56:59], v[108:111]
    ds_read_b128 v[188:191], v10 offset:39936
    v_mfma_f32_16x16x32_bf16 v[132:135], v[156:159], v[92:95], v[132:135]
    v_mfma_f32_16x16x32_bf16 v[112:115], v[160:163], v[56:59], v[112:115]
    v_mfma_f32_16x16x32_bf16 v[136:139], v[160:163], v[92:95], v[136:139]
    v_mfma_f32_16x16x32_bf16 v[116:119], v[164:167], v[56:59], v[116:119]
    v_mfma_f32_16x16x32_bf16 v[140:143], v[164:167], v[92:95], v[140:143]
    v_mfma_f32_16x16x32_bf16 v[120:123], v[168:171], v[56:59], v[120:123]
    v_mfma_f32_16x16x32_bf16 v[144:147], v[168:171], v[92:95], v[144:147]
    s_waitcnt vmcnt(2) lgkmcnt(0)
    s_barrier
    v_mfma_f32_16x16x32_bf16 v[148:151], v[96:99], v[96:99], v[148:151]
    ds_read_b128 v[152:155], v10 offset:40960
    v_mfma_f32_16x16x32_bf16 v[144:147], v[188:191], v[96:99], v[144:147]
    ds_read_b128 v[156:159], v10 offset:41984
    v_mfma_f32_16x16x32_bf16 v[128:131], v[172:175], v[96:99], v[128:131]
    ds_read_b128 v[160:163], v10 offset:43008
    v_mfma_f32_16x16x32_bf16 v[132:135], v[176:179], v[96:99], v[132:135]
    ds_read_b128 v[164:167], v10 offset:44032
    v_mfma_f32_16x16x32_bf16 v[136:139], v[180:183], v[96:99], v[136:139]
    ds_read_b128 v[168:171], v10 offset:45056
    v_mfma_f32_16x16x32_bf16 v[140:143], v[184:187], v[96:99], v[140:143]
    s_waitcnt vmcnt(0) lgkmcnt(0)
    v_mfma_f32_16x16x32_bf16 v[148:151], v[100:103], v[100:103], v[148:151]
    v_mfma_f32_16x16x32_bf16 v[144:147], v[168:171], v[100:103], v[144:147]
    v_mfma_f32_16x16x32_bf16 v[128:131], v[152:155], v[100:103], v[128:131]
    v_mfma_f32_16x16x32_bf16 v[132:135], v[156:159], v[100:103], v[132:135]
    v_mfma_f32_16x16x32_bf16 v[136:139], v[160:163], v[100:103], v[136:139]
    v_mfma_f32_16x16x32_bf16 v[140:143], v[164:167], v[100:103], v[140:143]
    v_mfma_f32_16x16x32_bf16 v[124:127], v[60:63], v[60:63], v[124:127]
    v_mfma_f32_16x16x32_bf16 v[120:123], v[188:191], v[60:63], v[120:123]
    v_mfma_f32_16x16x32_bf16 v[104:107], v[172:175], v[60:63], v[104:107]
    ds_write_b128 v14, v[148:151] offset:5120
    v_mfma_f32_16x16x32_bf16 v[108:111], v[176:179], v[60:63], v[108:111]
    v_mfma_f32_16x16x32_bf16 v[112:115], v[180:183], v[60:63], v[112:115]
    ds_write_b128 v14, v[144:147] offset:4096
    v_mfma_f32_16x16x32_bf16 v[116:119], v[184:187], v[60:63], v[116:119]
    v_mfma_f32_16x16x32_bf16 v[124:127], v[64:67], v[64:67], v[124:127]
    ds_write_b128 v14, v[128:131] offset:0
    v_mfma_f32_16x16x32_bf16 v[120:123], v[168:171], v[64:67], v[120:123]
    v_mfma_f32_16x16x32_bf16 v[104:107], v[152:155], v[64:67], v[104:107]
    ds_write_b128 v14, v[132:135] offset:1024
    v_mfma_f32_16x16x32_bf16 v[108:111], v[156:159], v[64:67], v[108:111]
    v_mfma_f32_16x16x32_bf16 v[112:115], v[160:163], v[64:67], v[112:115]
    ds_write_b128 v14, v[136:139] offset:2048
    v_mfma_f32_16x16x32_bf16 v[116:119], v[164:167], v[64:67], v[116:119]
    ds_write_b128 v14, v[140:143] offset:3072
    s_waitcnt lgkmcnt(0)
    s_barrier
    ds_read_b128 v[148:151], v15 offset:5120
    ds_read_b128 v[144:147], v15 offset:4096
    ds_read_b128 v[128:131], v15 offset:0
    ds_read_b128 v[132:135], v15 offset:1024
    ds_read_b128 v[136:139], v15 offset:2048
    ds_read_b128 v[140:143], v15 offset:3072
    s_waitcnt lgkmcnt(4)
    v_pk_add_f32 v[124:125], v[124:125], v[148:149]
    v_pk_add_f32 v[120:121], v[120:121], v[144:145]
    v_pk_add_f32 v[126:127], v[126:127], v[150:151]
    v_pk_add_f32 v[122:123], v[122:123], v[146:147]
    v_cndmask_b32 v16, v124, v125, s[58:59]
    v_cndmask_b32 v16, v16, v126, s[60:61]
    v_cndmask_b32 v16, v16, v127, s[62:63]
    ds_bpermute_b32 v18, v24, v120
    ds_bpermute_b32 v17, v11, v16
    ds_read_b128 v[192:195], v25 offset:128
    ds_read_b128 v[196:199], v25 offset:192
    ds_read_b128 v[200:203], v25 offset:256
    ds_read_b128 v[204:207], v25 offset:320
    ds_read_b128 v[208:211], v25 offset:384
    ds_read_b128 v[248:251], v25 offset:0
    ds_read_b128 v[252:255], v25 offset:64
    s_waitcnt lgkmcnt(9)
    v_pk_add_f32 v[104:105], v[104:105], v[128:129]
    v_pk_add_f32 v[106:107], v[106:107], v[130:131]
    v_pk_add_f32 v[108:109], v[108:109], v[132:133]
    v_pk_add_f32 v[110:111], v[110:111], v[134:135]
    v_pk_add_f32 v[112:113], v[112:113], v[136:137]
    v_pk_add_f32 v[114:115], v[114:115], v[138:139]
    v_pk_add_f32 v[116:117], v[116:117], v[140:141]
    v_pk_add_f32 v[118:119], v[118:119], v[142:143]
    s_mov_b32 s56, 0x3ae38e39
    s_waitcnt lgkmcnt(7)
    v_add_u32 v20, 0, v5
    s_cmp_eq_u32 s14, 1
    s_cbranch_scc1 q_noT
    ds_read_b128 v[152:155], v20 offset:0
    ds_read_b128 v[156:159], v20 offset:1024
    ds_read_b128 v[160:163], v20 offset:2048
    ds_read_b128 v[164:167], v20 offset:3072
    ds_read_b128 v[168:171], v20 offset:4096
    ds_read_b128 v[172:175], v20 offset:10240
    ds_read_b128 v[176:179], v20 offset:11264
    ds_read_b128 v[180:183], v20 offset:12288
    ds_read_b128 v[184:187], v20 offset:13312
    ds_read_b128 v[188:191], v20 offset:14336
q_noT:
    v_mul_f32 v18, s56, v18
    v_mul_f32 v17, s56, v17
    v_fma_f32 v17, -v18, v18, v17
    v_max_f32 v17, 0, v17
    v_cvt_pk_bf16_f32 v19, v18, v18
    v_lshlrev_b32 v18, 16, v19
    v_cvt_pk_bf16_f32 v19, v17, v17
    v_lshlrev_b32 v17, 16, v19
    v_add_f32 v17, 0x3727c5ac, v17
    v_cvt_pk_bf16_f32 v19, v17, v17
    v_lshlrev_b32 v17, 16, v19
    v_sqrt_f32 v17, v17
    s_nop 0
    v_cvt_pk_bf16_f32 v19, v17, v17
    v_lshlrev_b32 v17, 16, v19
    v_rcp_f32 v16, v17
    s_waitcnt lgkmcnt(0)
    s_mov_b32 s16, 0
    s_cmp_eq_u32 s14, 1
    s_cbranch_scc1 B_epi
    s_barrier
    v_pk_fma_f32 v[104:105], v[192:193], v[18:19], v[104:105] op_sel_hi:[1,0,1] neg_lo:[0,1,0] neg_hi:[0,1,0]
    v_pk_fma_f32 v[106:107], v[194:195], v[18:19], v[106:107] op_sel_hi:[1,0,1] neg_lo:[0,1,0] neg_hi:[0,1,0]
    v_pk_mul_f32 v[104:105], v[104:105], v[16:17] op_sel_hi:[1,0]
    v_pk_mul_f32 v[106:107], v[106:107], v[16:17] op_sel_hi:[1,0]
    v_cvt_pk_bf16_f32 v220, v104, v105
    v_cvt_pk_bf16_f32 v221, v106, v107
    v_pk_fma_f32 v[108:109], v[196:197], v[18:19], v[108:109] op_sel_hi:[1,0,1] neg_lo:[0,1,0] neg_hi:[0,1,0]
    v_pk_fma_f32 v[110:111], v[198:199], v[18:19], v[110:111] op_sel_hi:[1,0,1] neg_lo:[0,1,0] neg_hi:[0,1,0]
    v_pk_mul_f32 v[108:109], v[108:109], v[16:17] op_sel_hi:[1,0]
    v_pk_mul_f32 v[110:111], v[110:111], v[16:17] op_sel_hi:[1,0]
    v_cvt_pk_bf16_f32 v222, v108, v109
    v_cvt_pk_bf16_f32 v223, v110, v111
    v_pk_fma_f32 v[120:121], v[208:209], v[18:19], v[120:121] op_sel_hi:[1,0,1] neg_lo:[0,1,0] neg_hi:[0,1,0]
    v_pk_fma_f32 v[122:123], v[210:211], v[18:19], v[122:123] op_sel_hi:[1,0,1] neg_lo:[0,1,0] neg_hi:[0,1,0]
    v_pk_mul_f32 v[120:121], v[120:121], v[16:17] op_sel_hi:[1,0]
    v_pk_mul_f32 v[122:123], v[122:123], v[16:17] op_sel_hi:[1,0]
    v_cvt_pk_bf16_f32 v228, v120, v121
    v_cvt_pk_bf16_f32 v229, v122, v123
    v_mov_b32 v230, 0
    v_mov_b32 v231, 0
    v_and_b32 v22, 127, v6
    v_mul_u32_u24 v22, 224, v22
    v_add_u32 v22, 34816, v22
    v_lshl_add_u32 v21, v4, 3, v22
    v_mfma_f32_16x16x32_bf16 v[128:131], v[152:155], v[220:223], 0
    v_mfma_f32_16x16x32_bf16 v[132:135], v[156:159], v[220:223], 0
    v_mfma_f32_16x16x32_bf16 v[136:139], v[160:163], v[220:223], 0
    v_mfma_f32_16x16x32_bf16 v[140:143], v[164:167], v[220:223], 0
    v_mfma_f32_16x16x32_bf16 v[144:147], v[168:171], v[220:223], 0
    v_mfma_f32_16x16x32_bf16 v[128:131], v[172:175], v[228:231], v[128:131]
    v_mfma_f32_16x16x32_bf16 v[132:135], v[176:179], v[228:231], v[132:135]
    v_mfma_f32_16x16x32_bf16 v[136:139], v[180:183], v[228:231], v[136:139]
    v_mfma_f32_16x16x32_bf16 v[140:143], v[184:187], v[228:231], v[140:143]
    v_mfma_f32_16x16x32_bf16 v[144:147], v[188:191], v[228:231], v[144:147]
    v_pk_fma_f32 v[112:113], v[200:201], v[18:19], v[112:113] op_sel_hi:[1,0,1] neg_lo:[0,1,0] neg_hi:[0,1,0]
    v_pk_fma_f32 v[114:115], v[202:203], v[18:19], v[114:115] op_sel_hi:[1,0,1] neg_lo:[0,1,0] neg_hi:[0,1,0]
    v_pk_mul_f32 v[112:113], v[112:113], v[16:17] op_sel_hi:[1,0]
    v_pk_mul_f32 v[114:115], v[114:115], v[16:17] op_sel_hi:[1,0]
    v_cvt_pk_bf16_f32 v224, v112, v113
    v_cvt_pk_bf16_f32 v225, v114, v115
    v_pk_fma_f32 v[116:117], v[204:205], v[18:19], v[116:117] op_sel_hi:[1,0,1] neg_lo:[0,1,0] neg_hi:[0,1,0]
    v_pk_fma_f32 v[118:119], v[206:207], v[18:19], v[118:119] op_sel_hi:[1,0,1] neg_lo:[0,1,0] neg_hi:[0,1,0]
    v_pk_mul_f32 v[116:117], v[116:117], v[16:17] op_sel_hi:[1,0]
    v_pk_mul_f32 v[118:119], v[118:119], v[16:17] op_sel_hi:[1,0]
    v_cvt_pk_bf16_f32 v226, v116, v117
    v_cvt_pk_bf16_f32 v227, v118, v119
    ds_read_b128 v[192:195], v20 offset:5120
    ds_read_b128 v[196:199], v20 offset:6144
    ds_read_b128 v[200:203], v20 offset:7168
    ds_read_b128 v[204:207], v20 offset:8192
    ds_read_b128 v[208:211], v20 offset:9216
    ds_write_b64 v21, v[224:225] offset:128
    ds_write_b64 v21, v[226:227] offset:160
    v_mov_b32 v12, v228
    v_mov_b32 v13, 0x3f80
    v_mov_b32 v14, v229
    v_mov_b32 v15, 0x3f80
    s_mov_b32 exec_lo, 0
    s_mov_b32 exec_hi, 0xffff
    ds_write_b128 v22, v[12:15] offset:208
    s_mov_b64 exec, -1
    s_mov_b32 s56, 0x3fb8aa3b
    v_max3_f32 v12, v128, v129, v130
    v_max3_f32 v13, v131, v132, v133
    v_max3_f32 v12, v12, v134, v135
    v_max3_f32 v13, v13, v136, v137
    v_max3_f32 v12, v12, v138, v139
    v_max3_f32 v13, v13, v140, v141
    v_max3_f32 v12, v12, v142, v143
    v_max3_f32 v13, v13, v144, v145
    v_max_f32 v12, v12, v13
    v_mul_f32 v12, s56, v12
    v_pk_fma_f32 v[128:129], v[128:129], s[56:57], v[12:13] op_sel_hi:[1,0,0] neg_lo:[0,0,1] neg_hi:[0,0,1]
    s_lshl_b32 s31, s26, 10
    s_add_u32 m0, s31, 71680
    s_mul_i32 s29, s13, 92160
    s_add_u32 s31, s31, s29
    s_mul_i32 s29, s14, 0x100000
    s_add_u32 s31, s31, s29
    s_add_u32 s31, s31, 0x400000
    buffer_load_dwordx4 v5, s[32:35], s31 offen offset:0  lds
    v_pk_fma_f32 v[130:131], v[130:131], s[56:57], v[12:13] op_sel_hi:[1,0,0] neg_lo:[0,0,1] neg_hi:[0,0,1]
    v_exp_f32 v128, v128
    v_pk_fma_f32 v[132:133], v[132:133], s[56:57], v[12:13] op_sel_hi:[1,0,0] neg_lo:[0,0,1] neg_hi:[0,0,1]
    v_exp_f32 v129, v129
    v_exp_f32 v130, v130
    v_pk_fma_f32 v[134:135], v[134:135], s[56:57], v[12:13] op_sel_hi:[1,0,0] neg_lo:[0,0,1] neg_hi:[0,0,1]
    v_exp_f32 v131, v131
    v_exp_f32 v132, v132
    v_pk_fma_f32 v[136:137], v[136:137], s[56:57], v[12:13] op_sel_hi:[1,0,0] neg_lo:[0,0,1] neg_hi:[0,0,1]
    v_exp_f32 v133, v133
    v_pk_add_f32 v[14:15], v[128:129], v[130:131]
    s_add_u32 m0, m0, 8192
    s_add_u32 s31, s31, 8192
    buffer_load_dwordx4 v5, s[32:35], s31 offen offset:0  lds
    v_exp_f32 v134, v134
    v_pk_fma_f32 v[138:139], v[138:139], s[56:57], v[12:13] op_sel_hi:[1,0,0] neg_lo:[0,0,1] neg_hi:[0,0,1]
    v_exp_f32 v135, v135
    v_pk_add_f32 v[14:15], v[14:15], v[132:133]
    v_exp_f32 v136, v136
    v_pk_fma_f32 v[140:141], v[140:141], s[56:57], v[12:13] op_sel_hi:[1,0,0] neg_lo:[0,0,1] neg_hi:[0,0,1]
    v_exp_f32 v137, v137
    v_pk_add_f32 v[14:15], v[14:15], v[134:135]
    v_exp_f32 v138, v138
    v_pk_fma_f32 v[142:143], v[142:143], s[56:57], v[12:13] op_sel_hi:[1,0,0] neg_lo:[0,0,1] neg_hi:[0,0,1]
    v_exp_f32 v139, v139
    s_add_u32 m0, m0, 8192
    s_add_u32 s31, s31, 8192
    buffer_load_dwordx4 v5, s[32:35], s31 offen offset:0  lds
    v_pk_add_f32 v[14:15], v[14:15], v[136:137]
    v_exp_f32 v140, v140
    v_pk_fma_f32 v[144:145], v[144:145], s[56:57], v[12:13] op_sel_hi:[1,0,0] neg_lo:[0,0,1] neg_hi:[0,0,1]
    v_exp_f32 v141, v141
    v_exp_f32 v142, v142
    v_pk_add_f32 v[14:15], v[14:15], v[138:139]
    v_exp_f32 v143, v143
    v_pk_add_f32 v[14:15], v[14:15], v[140:141]
    v_exp_f32 v144, v144
    v_pk_add_f32 v[14:15], v[14:15], v[142:143]
    v_exp_f32 v145, v145
    s_add_u32 m0, m0, 8192
    s_add_u32 s31, s31, 8192
    buffer_load_dwordx4 v5, s[32:35], s31 offen offset:0  lds
    s_nop 0
    v_pk_add_f32 v[14:15], v[14:15], v[144:145]
    v_add_f32 v14, v14, v15
    v_rcp_f32 v14, v14
    s_nop 0
    v_pk_mul_f32 v[128:129], v[128:129], v[14:15] op_sel_hi:[1,0]
    v_pk_mul_f32 v[130:131], v[130:131], v[14:15] op_sel_hi:[1,0]
    v_pk_mul_f32 v[132:133], v[132:133], v[14:15] op_sel_hi:[1,0]
    v_pk_mul_f32 v[134:135], v[134:135], v[14:15] op_sel_hi:[1,0]
    v_pk_mul_f32 v[136:137], v[136:137], v[14:15] op_sel_hi:[1,0]
    v_pk_mul_f32 v[138:139], v[138:139], v[14:15] op_sel_hi:[1,0]
    s_add_u32 m0, m0, 8192
    s_add_u32 s31, s31, 8192
    buffer_load_dwordx4 v5, s[32:35], s31 offen offset:0  lds
    v_pk_mul_f32 v[140:141], v[140:141], v[14:15] op_sel_hi:[1,0]
    v_pk_mul_f32 v[142:143], v[142:143], v[14:15] op_sel_hi:[1,0]
    v_pk_mul_f32 v[144:145], v[144:145], v[14:15] op_sel_hi:[1,0]
    v_cvt_pk_bf16_f32 v128, v128, v129
    v_cvt_pk_bf16_f32 v129, v130, v131
    v_cvt_pk_bf16_f32 v130, v132, v133
    v_cvt_pk_bf16_f32 v131, v134, v135
    v_cvt_pk_bf16_f32 v132, v136, v137
    v_cvt_pk_bf16_f32 v133, v138, v139
    v_cvt_pk_bf16_f32 v134, v140, v141
    v_cvt_pk_bf16_f32 v135, v142, v143
    s_add_u32 m0, m0, 8192
    s_add_u32 s31, s31, 8192
    buffer_load_dwordx4 v5, s[32:35], s31 offen offset:0  lds
    v_cvt_pk_bf16_f32 v136, v144, v145
    v_lshl_add_u32 v21, v4, 5, v22
    v_lshl_add_u32 v24, v4, 2, v22
    ds_write_b128 v21, v[128:131]
    ds_write_b128 v21, v[132:135] offset:16
    ds_write_b32 v24, v136 offset:192
    s_lshr_b32 s64, s10, 1
    s_mul_i32 s64, s64, 94208
    s_add_u32 s64, s64, 0x660000
    s_mul_i32 s65, s25, 5888
    s_add_u32 s64, s64, s65
    s_lshr_b32 s65, s10, 1
    s_lshl_b32 s65, s65, 4
    s_add_u32 s65, s65, s25
    s_lshl_b32 s65, s65, 11
    s_add_u32 s65, s65, 0x740000
    s_waitcnt lgkmcnt(0)
    s_barrier
    s_cmp_ge_u32 s26, 6
    s_cbranch_scc1 A_q
    s_cmp_ge_u32 s26, 3
    s_cselect_b32 s57, 1, 0
    s_mul_i32 s58, s57, 3
    s_sub_u32 s58, s26, s58
    s_lshl_b32 s59, s57, 6
    s_lshl_b32 s60, s58, 5
    s_add_u32 s59, s59, s60
    s_lshl_b32 s60, s57, 3
    s_add_u32 s61, s60, 192
    s_cmp_eq_u32 s58, 2
    s_cselect_b32 s59, s61, s59
    s_add_u32 s60, s60, 208
    s_lshl_b32 s61, s57, 5
    s_add_u32 s61, s61, 128
    v_lshrrev_b32 v24, 2, v3
    v_lshl_add_u32 v24, v4, 2, v24
    v_mul_u32_u24 v24, 224, v24
    v_and_b32 v25, 3, v3
    v_lshl_add_u32 v24, v25, 3, v24
    v_add_u32 v24, 34816, v24
    v_add_u32 v25, s59, v24
    v_add_u32 v26, s61, v24
    v_add_u32 v27, s60, v24
    ds_read_b64_tr_b16 v[104:105], v25 offset:0
    ds_read_b64_tr_b16 v[128:129], v26 offset:0
    ds_read_b64_tr_b16 v[172:173], v27 offset:0
    ds_read_b64_tr_b16 v[106:107], v25 offset:3584
    ds_read_b64_tr_b16 v[130:131], v26 offset:3584
    ds_read_b64_tr_b16 v[174:175], v27 offset:3584
    ds_read_b64_tr_b16 v[108:109], v25 offset:7168
    ds_read_b64_tr_b16 v[132:133], v26 offset:7168
    ds_read_b64_tr_b16 v[176:177], v27 offset:7168
    ds_read_b64_tr_b16 v[110:111], v25 offset:10752
    ds_read_b64_tr_b16 v[134:135], v26 offset:10752
    ds_read_b64_tr_b16 v[178:179], v27 offset:10752
    ds_read_b64_tr_b16 v[112:113], v25 offset:14336
    ds_read_b64_tr_b16 v[136:137], v26 offset:14336
    ds_read_b64_tr_b16 v[180:181], v27 offset:14336
    ds_read_b64_tr_b16 v[114:115], v25 offset:17920
    ds_read_b64_tr_b16 v[138:139], v26 offset:17920
    ds_read_b64_tr_b16 v[182:183], v27 offset:17920
    ds_read_b64_tr_b16 v[116:117], v25 offset:21504
    ds_read_b64_tr_b16 v[140:141], v26 offset:21504
    ds_read_b64_tr_b16 v[184:185], v27 offset:21504
    ds_read_b64_tr_b16 v[118:119], v25 offset:25088
    ds_read_b64_tr_b16 v[142:143], v26 offset:25088
    ds_read_b64_tr_b16 v[186:187], v27 offset:25088
    s_mul_i32 s59, s57, 2944
    s_mul_i32 s60, s58, 1216
    s_add_u32 s59, s59, s60
    s_add_u32 s59, s59, s64
    v_lshlrev_b32 v28, 2, v1
    s_cmp_eq_u32 s58, 2
    s_cbranch_scc1 A_kvt
    s_waitcnt lgkmcnt(14)
    v_mfma_f32_16x16x32_bf16 v[120:123], v[128:131], v[104:107], 0
    v_mfma_f32_16x16x32_bf16 v[124:127], v[172:175], v[104:107], 0
    s_waitcnt lgkmcnt(12)
    v_mfma_f32_16x16x32_bf16 v[120:123], v[132:135], v[108:111], v[120:123]
    v_mfma_f32_16x16x32_bf16 v[124:127], v[176:179], v[108:111], v[124:127]
    s_waitcnt lgkmcnt(6)
    v_mfma_f32_16x16x32_bf16 v[120:123], v[136:139], v[112:115], v[120:123]
    v_mfma_f32_16x16x32_bf16 v[124:127], v[180:183], v[112:115], v[124:127]
    s_waitcnt lgkmcnt(0)
    v_mfma_f32_16x16x32_bf16 v[120:123], v[140:143], v[116:119], v[120:123]
    v_mfma_f32_16x16x32_bf16 v[124:127], v[184:187], v[116:119], v[124:127]
    s_nop 7
    buffer_atomic_add_f32 v120, v28, s[32:35], s59 offen offset:0
    buffer_atomic_add_f32 v121, v28, s[32:35], s59 offen offset:256
    buffer_atomic_add_f32 v122, v28, s[32:35], s59 offen offset:512
    buffer_atomic_add_f32 v123, v28, s[32:35], s59 offen offset:768
    s_mov_b64 exec, 0xffff
    buffer_atomic_add_f32 v124, v28, s[32:35], s59 offen offset:1024
    buffer_atomic_add_f32 v125, v28, s[32:35], s59 offen offset:1088
    buffer_atomic_add_f32 v126, v28, s[32:35], s59 offen offset:1152
    s_mov_b64 exec, -1
    s_branch A_q
A_kvt:
    s_waitcnt lgkmcnt(14)
    v_mfma_f32_16x16x32_bf16 v[120:123], v[104:107], v[128:131], 0
    v_mfma_f32_16x16x32_bf16 v[124:127], v[104:107], v[172:175], 0
    s_waitcnt lgkmcnt(12)
    v_mfma_f32_16x16x32_bf16 v[120:123], v[108:111], v[132:135], v[120:123]
    v_mfma_f32_16x16x32_bf16 v[124:127], v[108:111], v[176:179], v[124:127]
    s_waitcnt lgkmcnt(6)
    v_mfma_f32_16x16x32_bf16 v[120:123], v[112:115], v[136:139], v[120:123]
    v_mfma_f32_16x16x32_bf16 v[124:127], v[112:115], v[180:183], v[124:127]
    s_waitcnt lgkmcnt(0)
    v_mfma_f32_16x16x32_bf16 v[120:123], v[116:119], v[140:143], v[120:123]
    v_mfma_f32_16x16x32_bf16 v[124:127], v[116:119], v[184:187], v[124:127]
    s_mov_b64 exec, 0xffff
    s_nop 7
    buffer_atomic_add_f32 v120, v28, s[32:35], s59 offen offset:0
    buffer_atomic_add_f32 v121, v28, s[32:35], s59 offen offset:128
    buffer_atomic_add_f32 v122, v28, s[32:35], s59 offen offset:256
    buffer_atomic_add_f32 v123, v28, s[32:35], s59 offen offset:384
    s_mov_b64 exec, 7
    buffer_atomic_add_f32 v124, v28, s[32:35], s59 offen offset:64
    buffer_atomic_add_f32 v125, v28, s[32:35], s59 offen offset:192
    buffer_atomic_add_f32 v126, v28, s[32:35], s59 offen offset:320
    buffer_atomic_add_f32 v127, v28, s[32:35], s59 offen offset:448
    s_mov_b64 exec, -1
A_q:
    ds_read_b128 v[104:107], v7 offset:0
    ds_read_b128 v[108:111], v7 offset:1024
    ds_read_b128 v[112:115], v7 offset:2048
    ds_read_b128 v[116:119], v7 offset:3072
    ds_read_b128 v[120:123], v7 offset:4096
    ds_read_b128 v[124:127], v7 offset:5120
    ds_read_b128 v[128:131], v7 offset:6144
    ds_read_b128 v[132:135], v7 offset:7168
    s_lshl_b32 s56, s26, 11
    s_add_u32 s56, s56, 17408
    v_add_u32 v14, s56, v5
    s_xor_b32 s56, s26, 4
    s_lshl_b32 s56, s56, 11
    s_add_u32 s56, s56, 17408
    v_add_u32 v15, s56, v5
    ds_read_b128 v[136:139], v7 offset:8192
    ds_read_b128 v[140:143], v7 offset:9216
    s_waitcnt lgkmcnt(8)
    v_mfma_f32_16x16x32_bf16 v[240:243], v[104:107], v[68:71], 0
    v_mfma_f32_16x16x32_bf16 v[244:247], v[108:111], v[68:71], 0
    v_mfma_f32_16x16x32_bf16 v[232:235], v[104:107], v[32:35], 0
    v_mfma_f32_16x16x32_bf16 v[236:239], v[108:111], v[32:35], 0
    ds_read_b128 v[144:147], v7 offset:10240
    ds_read_b128 v[148:151], v7 offset:11264
    s_waitcnt lgkmcnt(8)
    v_mfma_f32_16x16x32_bf16 v[240:243], v[112:115], v[72:75], v[240:243]
    v_mfma_f32_16x16x32_bf16 v[244:247], v[116:119], v[72:75], v[244:247]
    v_mfma_f32_16x16x32_bf16 v[232:235], v[112:115], v[36:39], v[232:235]
    v_mfma_f32_16x16x32_bf16 v[236:239], v[116:119], v[36:39], v[236:239]
    ds_read_b128 v[172:175], v7 offset:12288
    ds_read_b128 v[176:179], v7 offset:13312
    s_waitcnt lgkmcnt(8)
    v_mfma_f32_16x16x32_bf16 v[240:243], v[120:123], v[76:79], v[240:243]
    v_mfma_f32_16x16x32_bf16 v[244:247], v[124:127], v[76:79], v[244:247]
    v_mfma_f32_16x16x32_bf16 v[232:235], v[120:123], v[40:43], v[232:235]
    v_mfma_f32_16x16x32_bf16 v[236:239], v[124:127], v[40:43], v[236:239]
    ds_read_b128 v[180:183], v7 offset:14336
    ds_read_b128 v[184:187], v7 offset:15360
    s_waitcnt lgkmcnt(8)
    v_mfma_f32_16x16x32_bf16 v[240:243], v[128:131], v[80:83], v[240:243]
    v_mfma_f32_16x16x32_bf16 v[244:247], v[132:135], v[80:83], v[244:247]
    v_mfma_f32_16x16x32_bf16 v[232:235], v[128:131], v[44:47], v[232:235]
    v_mfma_f32_16x16x32_bf16 v[236:239], v[132:135], v[44:47], v[236:239]
    ds_read_b128 v[188:191], v7 offset:16384
    ds_read_b128 v[212:215], v7 offset:17408
    s_waitcnt lgkmcnt(8)
    v_mfma_f32_16x16x32_bf16 v[240:243], v[136:139], v[84:87], v[240:243]
    v_mfma_f32_16x16x32_bf16 v[244:247], v[140:143], v[84:87], v[244:247]
    v_mfma_f32_16x16x32_bf16 v[232:235], v[136:139], v[48:51], v[232:235]
    v_mfma_f32_16x16x32_bf16 v[236:239], v[140:143], v[48:51], v[236:239]
    s_waitcnt lgkmcnt(6)
    v_mfma_f32_16x16x32_bf16 v[240:243], v[144:147], v[88:91], v[240:243]
    v_mfma_f32_16x16x32_bf16 v[244:247], v[148:151], v[88:91], v[244:247]
    v_mfma_f32_16x16x32_bf16 v[232:235], v[144:147], v[52:55], v[232:235]
    v_mfma_f32_16x16x32_bf16 v[236:239], v[148:151], v[52:55], v[236:239]
    s_waitcnt lgkmcnt(4)
    v_mfma_f32_16x16x32_bf16 v[240:243], v[172:175], v[92:95], v[240:243]
    v_mfma_f32_16x16x32_bf16 v[244:247], v[176:179], v[92:95], v[244:247]
    v_mfma_f32_16x16x32_bf16 v[232:235], v[172:175], v[56:59], v[232:235]
    v_mfma_f32_16x16x32_bf16 v[236:239], v[176:179], v[56:59], v[236:239]
    s_waitcnt lgkmcnt(2)
    v_mfma_f32_16x16x32_bf16 v[240:243], v[180:183], v[96:99], v[240:243]
    v_mfma_f32_16x16x32_bf16 v[244:247], v[184:187], v[96:99], v[244:247]
    v_mfma_f32_16x16x32_bf16 v[232:235], v[180:183], v[60:63], v[232:235]
    v_mfma_f32_16x16x32_bf16 v[236:239], v[184:187], v[60:63], v[236:239]
    s_waitcnt lgkmcnt(0)
    v_mfma_f32_16x16x32_bf16 v[240:243], v[188:191], v[100:103], v[240:243]
    v_mfma_f32_16x16x32_bf16 v[244:247], v[212:215], v[100:103], v[244:247]
    v_mfma_f32_16x16x32_bf16 v[232:235], v[188:191], v[64:67], v[232:235]
    v_mfma_f32_16x16x32_bf16 v[236:239], v[212:215], v[64:67], v[236:239]
    s_nop 5
    ds_write_b128 v14, v[240:243] offset:0
    ds_write_b128 v14, v[244:247] offset:1024
    s_waitcnt lgkmcnt(0)
    s_barrier
    ds_read_b128 v[240:243], v15 offset:0
    ds_read_b128 v[244:247], v15 offset:1024
    s_waitcnt lgkmcnt(0)
    v_pk_add_f32 v[232:233], v[232:233], v[240:241]
    v_pk_add_f32 v[234:235], v[234:235], v[242:243]
    v_pk_add_f32 v[236:237], v[236:237], v[244:245]
    v_pk_add_f32 v[238:239], v[238:239], v[246:247]
    v_pk_fma_f32 v[232:233], v[248:249], v[18:19], v[232:233] op_sel_hi:[1,0,1] neg_lo:[0,1,0] neg_hi:[0,1,0]
    v_pk_fma_f32 v[234:235], v[250:251], v[18:19], v[234:235] op_sel_hi:[1,0,1] neg_lo:[0,1,0] neg_hi:[0,1,0]
    v_pk_mul_f32 v[232:233], v[232:233], v[16:17] op_sel_hi:[1,0]
    v_pk_mul_f32 v[234:235], v[234:235], v[16:17] op_sel_hi:[1,0]
    v_cvt_pk_bf16_f32 v104, v232, v233
    v_cvt_pk_bf16_f32 v105, v234, v235
    v_pk_fma_f32 v[236:237], v[252:253], v[18:19], v[236:237] op_sel_hi:[1,0,1] neg_lo:[0,1,0] neg_hi:[0,1,0]
    v_pk_fma_f32 v[238:239], v[254:255], v[18:19], v[238:239] op_sel_hi:[1,0,1] neg_lo:[0,1,0] neg_hi:[0,1,0]
    v_pk_mul_f32 v[236:237], v[236:237], v[16:17] op_sel_hi:[1,0]
    v_pk_mul_f32 v[238:239], v[238:239], v[16:17] op_sel_hi:[1,0]
    v_cvt_pk_bf16_f32 v106, v236, v237
    v_cvt_pk_bf16_f32 v107, v238, v239
    s_mul_i32 s57, s27, 4608
    s_add_u32 s57, s57, 34816
    v_mfma_f32_16x16x32_bf16 v[108:111], v[152:155], v[104:107], 0
    v_mfma_f32_16x16x32_bf16 v[112:115], v[156:159], v[104:107], 0
    v_mfma_f32_16x16x32_bf16 v[116:119], v[160:163], v[104:107], 0
    v_mfma_f32_16x16x32_bf16 v[120:123], v[164:167], v[104:107], 0
    v_mfma_f32_16x16x32_bf16 v[124:127], v[168:171], v[104:107], 0
    v_mfma_f32_16x16x32_bf16 v[108:111], v[192:195], v[228:231], v[108:111]
    v_mfma_f32_16x16x32_bf16 v[112:115], v[196:199], v[228:231], v[112:115]
    v_mfma_f32_16x16x32_bf16 v[116:119], v[200:203], v[228:231], v[116:119]
    v_mfma_f32_16x16x32_bf16 v[120:123], v[204:207], v[228:231], v[120:123]
    v_mfma_f32_16x16x32_bf16 v[124:127], v[208:211], v[228:231], v[124:127]
    v_lshrrev_b32 v24, 1, v4
    v_mul_u32_u24 v24, 2304, v24
    v_add_u32 v24, s57, v24
    v_and_b32 v25, 1, v4
    v_and_b32 v26, 31, v6
    v_lshl_add_u32 v22, v25, 10, v24
    v_lshl_add_u32 v22, v26, 4, v22
    v_lshl_add_u32 v23, v26, 3, v24
    v_lshl_add_u32 v23, v25, 2, v23
    s_mov_b32 s56, 0x3fb8aa3b
    v_mov_b32 v27, 33792
    v_mov_b32 v30, 1
    s_waitcnt vmcnt(0)
    s_mov_b64 exec, 1
    ds_add_rtn_u32 v28, v27, v30
    s_waitcnt lgkmcnt(0)
    v_readfirstlane_b32 s57, v28
    s_mov_b64 exec, -1
    s_cmp_lg_u32 s57, 7
    s_cbranch_scc1 A_noarr
    v_lshlrev_b32 v29, 7, v1
    v_mov_b32 v30, 1
    s_mov_b64 exec, 0xffff
    buffer_atomic_add v30, v29, s[32:35], s65 offen sc1
    s_mov_b64 exec, -1
A_noarr:
    v_max3_f32 v12, v108, v109, v110
    v_max3_f32 v13, v111, v112, v113
    v_max3_f32 v12, v12, v114, v115
    v_max3_f32 v13, v13, v116, v117
    v_max3_f32 v12, v12, v118, v119
    v_max3_f32 v13, v13, v120, v121
    v_max3_f32 v12, v12, v122, v123
    v_max3_f32 v13, v13, v124, v125
    v_max_f32 v12, v12, v13
    v_mul_f32 v12, s56, v12
    v_pk_fma_f32 v[108:109], v[108:109], s[56:57], v[12:13] op_sel_hi:[1,0,0] neg_lo:[0,0,1] neg_hi:[0,0,1]
    s_add_u32 m0, m0, 8192
    s_add_u32 s31, s31, 8192
    buffer_load_dwordx4 v5, s[32:35], s31 offen offset:0  lds
    v_pk_fma_f32 v[110:111], v[110:111], s[56:57], v[12:13] op_sel_hi:[1,0,0] neg_lo:[0,0,1] neg_hi:[0,0,1]
    v_exp_f32 v108, v108
    v_pk_fma_f32 v[112:113], v[112:113], s[56:57], v[12:13] op_sel_hi:[1,0,0] neg_lo:[0,0,1] neg_hi:[0,0,1]
    v_exp_f32 v109, v109
    v_exp_f32 v110, v110
    v_pk_fma_f32 v[114:115], v[114:115], s[56:57], v[12:13] op_sel_hi:[1,0,0] neg_lo:[0,0,1] neg_hi:[0,0,1]
    v_exp_f32 v111, v111
    v_exp_f32 v112, v112
    v_pk_fma_f32 v[116:117], v[116:117], s[56:57], v[12:13] op_sel_hi:[1,0,0] neg_lo:[0,0,1] neg_hi:[0,0,1]
    v_exp_f32 v113, v113
    v_pk_add_f32 v[14:15], v[108:109], v[110:111]
    s_add_u32 m0, m0, 8192
    s_add_u32 s31, s31, 8192
    buffer_load_dwordx4 v5, s[32:35], s31 offen offset:0  lds
    v_exp_f32 v114, v114
    v_pk_fma_f32 v[118:119], v[118:119], s[56:57], v[12:13] op_sel_hi:[1,0,0] neg_lo:[0,0,1] neg_hi:[0,0,1]
    v_exp_f32 v115, v115
    v_pk_add_f32 v[14:15], v[14:15], v[112:113]
    v_exp_f32 v116, v116
    v_pk_fma_f32 v[120:121], v[120:121], s[56:57], v[12:13] op_sel_hi:[1,0,0] neg_lo:[0,0,1] neg_hi:[0,0,1]
    v_exp_f32 v117, v117
    v_pk_add_f32 v[14:15], v[14:15], v[114:115]
    v_exp_f32 v118, v118
    v_pk_fma_f32 v[122:123], v[122:123], s[56:57], v[12:13] op_sel_hi:[1,0,0] neg_lo:[0,0,1] neg_hi:[0,0,1]
    v_exp_f32 v119, v119
    s_add_u32 m0, m0, 8192
    s_add_u32 s31, s31, 8192
    buffer_load_dwordx4 v5, s[32:35], s31 offen offset:0  lds
    v_pk_add_f32 v[14:15], v[14:15], v[116:117]
    v_exp_f32 v120, v120
    v_pk_fma_f32 v[124:125], v[124:125], s[56:57], v[12:13] op_sel_hi:[1,0,0] neg_lo:[0,0,1] neg_hi:[0,0,1]
    v_exp_f32 v121, v121
    v_exp_f32 v122, v122
    v_pk_add_f32 v[14:15], v[14:15], v[118:119]
    v_exp_f32 v123, v123
    v_pk_add_f32 v[14:15], v[14:15], v[120:121]
    v_exp_f32 v124, v124
    v_pk_add_f32 v[14:15], v[14:15], v[122:123]
    v_exp_f32 v125, v125
    s_add_u32 m0, m0, 8192
    s_add_u32 s31, s31, 8192
    buffer_load_dwordx4 v5, s[32:35], s31 offen offset:0  lds
    s_nop 0
    v_pk_add_f32 v[14:15], v[14:15], v[124:125]
    v_add_f32 v14, v14, v15
    v_rcp_f32 v14, v14
    s_nop 0
    v_pk_mul_f32 v[108:109], v[108:109], v[14:15] op_sel_hi:[1,0]
    v_pk_mul_f32 v[110:111], v[110:111], v[14:15] op_sel_hi:[1,0]
    v_pk_mul_f32 v[112:113], v[112:113], v[14:15] op_sel_hi:[1,0]
    v_pk_mul_f32 v[114:115], v[114:115], v[14:15] op_sel_hi:[1,0]
    v_pk_mul_f32 v[116:117], v[116:117], v[14:15] op_sel_hi:[1,0]
    v_pk_mul_f32 v[118:119], v[118:119], v[14:15] op_sel_hi:[1,0]
    s_add_u32 m0, m0, 8192
    s_add_u32 s31, s31, 8192
    buffer_load_dwordx4 v5, s[32:35], s31 offen offset:0  lds
    v_pk_mul_f32 v[120:121], v[120:121], v[14:15] op_sel_hi:[1,0]
    v_pk_mul_f32 v[122:123], v[122:123], v[14:15] op_sel_hi:[1,0]
    v_pk_mul_f32 v[124:125], v[124:125], v[14:15] op_sel_hi:[1,0]
    v_cvt_pk_bf16_f32 v108, v108, v109
    v_cvt_pk_bf16_f32 v109, v110, v111
    v_cvt_pk_bf16_f32 v110, v112, v113
    v_cvt_pk_bf16_f32 v111, v114, v115
    v_cvt_pk_bf16_f32 v112, v116, v117
    v_cvt_pk_bf16_f32 v113, v118, v119
    v_cvt_pk_bf16_f32 v114, v120, v121
    v_cvt_pk_bf16_f32 v115, v122, v123
    s_cmp_lt_u32 s26, 2
    s_cselect_b32 s29, 8192, 0
    s_add_u32 m0, m0, s29
    s_add_u32 s31, s31, s29
    buffer_load_dwordx4 v5, s[32:35], s31 offen offset:0  lds
    v_cvt_pk_bf16_f32 v116, v124, v125
    ds_write_b128 v22, v[108:111]
    ds_write_b128 v22, v[112:115] offset:512
    ds_write_b32 v23, v116 offset:2048
    s_lshl_b32 s56, s24, 7
    s_add_u32 s56, s56, s65
    s_waitcnt lgkmcnt(0)
    s_barrier
    s_lshl_b32 s57, s27, 1
    s_add_u32 s57, s57, s28
    s_mul_i32 s57, s57, 2304
    s_add_u32 s57, s57, 34816
    v_add_u32 v20, s57, v5
    v_and_b32 v3, 31, v1
    v_lshlrev_b32 v21, 3, v3
    v_add_u32 v21, s57, v21
    v_mov_b32 v40, 0
    v_mov_b32 v41, 0
    v_mov_b32 v42, 0
    v_mov_b32 v43, 0
    ds_read_b128 v[32:35], v20
    ds_read_b128 v[36:39], v20 offset:1024
    s_mov_b32 exec_hi, 0
    ds_read_b64 v[40:41], v21 offset:2048
    s_mov_b32 exec_hi, -1
    s_mul_i32 s58, s26, 3072
    s_add_u32 s58, s58, 0
    v_min_u32 v8, 18, v3
    v_and_b32 v9, 3, v8
    v_lshlrev_b32 v9, 8, v9
    v_lshrrev_b32 v4, 2, v8
    v_lshl_add_u32 v9, v4, 6, v9
    v_lshlrev_b32 v4, 6, v8
    v_cmp_gt_u32 vcc, 16, v8
    v_lshlrev_b32 v8, 2, v8
    v_add_u32 v8, s58, v8
    v_cndmask_b32 v9, v4, v9, vcc
    v_lshrrev_b32 v4, 5, v1
    v_lshl_add_u32 v9, v4, 5, v9
    v_add_u32 v9, s58, v9
    s_lshl_b32 s59, s24, 2
    s_add_u32 s59, s59, s27
    s_lshl_b32 s60, s25, 1
    s_add_u32 s60, s60, s28
    s_mul_i32 s61, s10, 0x240000
    s_mul_i32 s67, s59, 36864
    s_add_u32 s67, s67, s61
    s_add_u32 s67, s67, 0x3000000
    s_lshl_b32 s61, s60, 10
    s_and_b32 s62, s60, 1
    s_lshl_b32 s62, s62, 9
    s_sub_u32 s61, s61, s62
    s_add_u32 s66, s67, s61
    s_lshl_b32 s61, s60, 7
    s_add_u32 s67, s67, s61
    s_add_u32 s67, s67, 32768
    s_mul_i32 s57, s28, 2944
    s_add_u32 s57, s57, s64
    s_mov_b32 m0, s58
    s_waitcnt vmcnt(0)
    s_cmp_lg_u32 s26, 0
    s_cbranch_scc1 pl2_e
    v_mov_b32 v29, 0
    s_mov_b64 exec, 1
    s_mov_b32 s90, 0
pl2:
    buffer_load_dword v27, v29, s[32:35], s56 offen sc1
    s_waitcnt vmcnt(0)
    v_readfirstlane_b32 s91, v27
    s_add_u32 s90, s90, 1
    s_cmp_ge_u32 s90, 200000
    s_cbranch_scc1 pl2_d
    s_cmp_lt_u32 s91, 16
    s_cbranch_scc1 pl2
pl2_d:
    s_mov_b64 exec, -1
pl2_e:
    s_barrier
    buffer_load_dwordx4 v5, s[32:35], s57 offen offset:0 sc1 lds
    buffer_load_dwordx4 v5, s[32:35], s57 offen offset:1024 sc1 lds
    s_mov_b32 exec_hi, 0xffffff
    buffer_load_dwordx4 v5, s[32:35], s57 offen offset:2048 sc1 lds
    s_mov_b32 exec_hi, -1
    s_waitcnt vmcnt(0)
    ds_read_b128 v[48:51], v9
    ds_read_b128 v[52:55], v9 offset:16
    ds_read_b128 v[56:59], v9 offset:1216
    ds_read_b128 v[60:63], v9 offset:1232
    ds_read_b32 v64, v8 offset:2432
    ds_read_b32 v65, v8 offset:2560
    ds_read_b32 v66, v8 offset:2688
    ds_read_b32 v67, v8 offset:2816
    s_waitcnt lgkmcnt(0)
    v_cvt_pk_bf16_f32 v48, v48, v49
    v_cvt_pk_bf16_f32 v49, v50, v51
    v_cvt_pk_bf16_f32 v50, v52, v53
    v_cvt_pk_bf16_f32 v51, v54, v55
    v_cvt_pk_bf16_f32 v52, v56, v57
    v_cvt_pk_bf16_f32 v53, v58, v59
    v_cvt_pk_bf16_f32 v54, v60, v61
    v_cvt_pk_bf16_f32 v55, v62, v63
    v_cvt_pk_bf16_f32 v56, v64, v65
    v_cvt_pk_bf16_f32 v57, v66, v67
    v_mov_b32 v58, 0
    v_mov_b32 v59, 0
    s_nop 1
    v_mfma_f32_32x32x16_bf16 v[72:87], v[48:51], v[32:35], 0
    v_mfma_f32_32x32x16_bf16 v[72:87], v[52:55], v[36:39], v[72:87]
    v_mfma_f32_32x32x16_bf16 v[72:87], v[56:59], v[40:43], v[72:87]
    s_nop 6
    v_bfe_u32 v26, v1, 4, 1
    v_and_b32 v27, 15, v1
    v_lshlrev_b32 v27, 4, v27
    v_lshl_add_u32 v27, v26, 10, v27
    v_lshrrev_b32 v26, 5, v1
    v_lshl_add_u32 v28, v26, 8, v27
    v_lshlrev_b32 v27, 2, v1
    v_add_f32 v24, 0x358637bd, v82
    v_rcp_f32 v24, v24
    s_nop 0
    v_pk_mul_f32 v[72:73], v[72:73], v[24:25] op_sel_hi:[1,0]
    v_pk_mul_f32 v[74:75], v[74:75], v[24:25] op_sel_hi:[1,0]
    v_pk_mul_f32 v[76:77], v[76:77], v[24:25] op_sel_hi:[1,0]
    v_pk_mul_f32 v[78:79], v[78:79], v[24:25] op_sel_hi:[1,0]
    v_pk_mul_f32 v[80:81], v[80:81], v[24:25] op_sel_hi:[1,0]
    v_cvt_pk_bf16_f32 v72, v72, v73
    v_cvt_pk_bf16_f32 v73, v74, v75
    v_cvt_pk_bf16_f32 v74, v76, v77
    v_cvt_pk_bf16_f32 v75, v78, v79
    v_cvt_pk_bf16_f32 v76, v80, v81
    buffer_store_dwordx4 v[72:75], v28, s[32:35], s66 offen offset:0 sc1
    s_mov_b32 exec_hi, 0
    buffer_store_dword v76, v27, s[32:35], s67 offen offset:0 sc1
    s_mov_b32 exec_hi, -1
    s_mul_i32 s31, s28, 40960
    s_add_u32 s31, s31, 71680
    v_add_u32 v10, s31, v5
    s_lshl_b32 s31, s28, 11
    v_add_u32 v8, s31, v10
    s_xor_b32 s31, s31, 2048
    v_add_u32 v9, s31, v10
    ds_read_b128 v[72:75], v8 offset:0
    ds_read_b128 v[76:79], v8 offset:1024
    ds_read_b128 v[80:83], v9 offset:0
    ds_read_b128 v[84:87], v9 offset:1024
    ds_read_b128 v[88:91], v10 offset:4096
    ds_read_b128 v[92:95], v8 offset:5120
    ds_read_b128 v[96:99], v8 offset:6144
    ds_read_b128 v[100:103], v9 offset:5120
    ds_read_b128 v[104:107], v9 offset:6144
    ds_read_b128 v[108:111], v10 offset:9216
    ds_read_b128 v[112:115], v8 offset:10240
    ds_read_b128 v[116:119], v8 offset:11264
    ds_read_b128 v[120:123], v9 offset:10240
    ds_read_b128 v[124:127], v9 offset:11264
    ds_read_b128 v[128:131], v10 offset:14336
    ds_read_b128 v[132:135], v8 offset:15360
    ds_read_b128 v[136:139], v8 offset:16384
    ds_read_b128 v[140:143], v9 offset:15360
    ds_read_b128 v[144:147], v9 offset:16384
    ds_read_b128 v[148:151], v10 offset:19456
    ds_read_b128 v[152:155], v8 offset:20480
    ds_read_b128 v[156:159], v8 offset:21504
    ds_read_b128 v[160:163], v9 offset:20480
    ds_read_b128 v[164:167], v9 offset:21504
    ds_read_b128 v[168:171], v10 offset:24576
    ds_read_b128 v[172:175], v8 offset:25600
    ds_read_b128 v[176:179], v8 offset:26624
    ds_read_b128 v[180:183], v9 offset:25600
    ds_read_b128 v[184:187], v9 offset:26624
    ds_read_b128 v[188:191], v10 offset:29696
    ds_read_b128 v[192:195], v8 offset:30720
    ds_read_b128 v[196:199], v8 offset:31744
    ds_read_b128 v[200:203], v9 offset:30720
    ds_read_b128 v[204:207], v9 offset:31744
    ds_read_b128 v[208:211], v10 offset:34816
    ds_read_b128 v[212:215], v8 offset:35840
    ds_read_b128 v[216:219], v8 offset:36864
    ds_read_b128 v[220:223], v9 offset:35840
    ds_read_b128 v[224:227], v9 offset:36864
    ds_read_b128 v[228:231], v10 offset:39936
    s_mul_i32 s31, s28, -35840
    s_add_u32 s31, s31, 81920
    v_add_u32 v8, s31, v8
    v_add_u32 v9, s31, v9
    v_add_u32 v10, s31, v10
    ds_read_b128 v[232:235], v8 offset:0
    ds_read_b128 v[236:239], v8 offset:1024
    ds_read_b128 v[240:243], v9 offset:0
    ds_read_b128 v[244:247], v9 offset:1024
    ds_read_b128 v[248:251], v10 offset:4096
    s_waitcnt vmcnt(0)
    s_branch O_pub
B_epi:
    v_pk_fma_f32 v[104:105], v[192:193], v[18:19], v[104:105] op_sel_hi:[1,0,1] neg_lo:[0,1,0] neg_hi:[0,1,0]
    v_pk_fma_f32 v[106:107], v[194:195], v[18:19], v[106:107] op_sel_hi:[1,0,1] neg_lo:[0,1,0] neg_hi:[0,1,0]
    v_pk_mul_f32 v[104:105], v[104:105], v[16:17] op_sel_hi:[1,0]
    v_pk_mul_f32 v[106:107], v[106:107], v[16:17] op_sel_hi:[1,0]
    v_cvt_pk_bf16_f32 v220, v104, v105
    v_cvt_pk_bf16_f32 v221, v106, v107
    v_pk_fma_f32 v[108:109], v[196:197], v[18:19], v[108:109] op_sel_hi:[1,0,1] neg_lo:[0,1,0] neg_hi:[0,1,0]
    v_pk_fma_f32 v[110:111], v[198:199], v[18:19], v[110:111] op_sel_hi:[1,0,1] neg_lo:[0,1,0] neg_hi:[0,1,0]
    v_pk_mul_f32 v[108:109], v[108:109], v[16:17] op_sel_hi:[1,0]
    v_pk_mul_f32 v[110:111], v[110:111], v[16:17] op_sel_hi:[1,0]
    v_cvt_pk_bf16_f32 v222, v108, v109
    v_cvt_pk_bf16_f32 v223, v110, v111
    v_pk_fma_f32 v[112:113], v[200:201], v[18:19], v[112:113] op_sel_hi:[1,0,1] neg_lo:[0,1,0] neg_hi:[0,1,0]
    v_pk_fma_f32 v[114:115], v[202:203], v[18:19], v[114:115] op_sel_hi:[1,0,1] neg_lo:[0,1,0] neg_hi:[0,1,0]
    v_pk_mul_f32 v[112:113], v[112:113], v[16:17] op_sel_hi:[1,0]
    v_pk_mul_f32 v[114:115], v[114:115], v[16:17] op_sel_hi:[1,0]
    v_cvt_pk_bf16_f32 v224, v112, v113
    v_cvt_pk_bf16_f32 v225, v114, v115
    v_pk_fma_f32 v[116:117], v[204:205], v[18:19], v[116:117] op_sel_hi:[1,0,1] neg_lo:[0,1,0] neg_hi:[0,1,0]
    v_pk_fma_f32 v[118:119], v[206:207], v[18:19], v[118:119] op_sel_hi:[1,0,1] neg_lo:[0,1,0] neg_hi:[0,1,0]
    v_pk_mul_f32 v[116:117], v[116:117], v[16:17] op_sel_hi:[1,0]
    v_pk_mul_f32 v[118:119], v[118:119], v[16:17] op_sel_hi:[1,0]
    v_cvt_pk_bf16_f32 v226, v116, v117
    v_cvt_pk_bf16_f32 v227, v118, v119
    v_pk_fma_f32 v[120:121], v[208:209], v[18:19], v[120:121] op_sel_hi:[1,0,1] neg_lo:[0,1,0] neg_hi:[0,1,0]
    v_pk_fma_f32 v[122:123], v[210:211], v[18:19], v[122:123] op_sel_hi:[1,0,1] neg_lo:[0,1,0] neg_hi:[0,1,0]
    v_pk_mul_f32 v[120:121], v[120:121], v[16:17] op_sel_hi:[1,0]
    v_pk_mul_f32 v[122:123], v[122:123], v[16:17] op_sel_hi:[1,0]
    v_cvt_pk_bf16_f32 v228, v120, v121
    v_cvt_pk_bf16_f32 v229, v122, v123
    s_lshr_b32 s64, s10, 1
    s_lshl_b32 s64, s64, 23
    s_add_u32 s64, s64, 0x1300000
    s_lshl_b32 s65, s25, 19
    s_add_u32 s64, s64, s65
    v_lshlrev_b32 v20, 4, v6
    v_and_b32 v21, 1, v4
    v_lshl_add_u32 v22, v21, 18, v20
    v_lshrrev_b32 v23, 1, v4
    v_lshl_add_u32 v22, v23, 15, v22
    v_and_b32 v24, 127, v6
    v_mul_u32_u24 v25, 34112, v21
    v_lshl_add_u32 v25, v24, 4, v25
    v_mul_u32_u24 v27, 6208, v23
    v_add_u32 v27, v27, v25
    v_mul_u32_u24 v9, 5120, v21
    v_lshl_add_u32 v9, v24, 4, v9
    v_lshl_add_u32 v9, v23, 11, v9
    v_add_u32 v9, 88064, v9
    s_add_u32 s56, s64, 65536
    s_add_u32 s57, s64, 131072
    v_permlane16_swap_b32 v220, v222
    v_permlane16_swap_b32 v221, v223
    v_permlane16_swap_b32 v224, v226
    v_permlane16_swap_b32 v225, v227
    buffer_store_dwordx4 v[220:223], v22, s[32:35], s56 offen offset:0 sc1
    buffer_store_dwordx4 v[224:227], v22, s[32:35], s57 offen offset:0 sc1
    v_cmp_eq_u32 vcc, 2, v4
    v_mov_b32 v28, 0x3f80
    v_mov_b32 v12, v228
    v_cndmask_b32 v13, 0, v28, vcc
    v_mov_b32 v14, v229
    v_mov_b32 v15, v13
    v_lshlrev_b32 v28, 3, v6
    v_add_u32 v28, 245760, v28
    v_add_u32 v20, 196608, v20
    v_cndmask_b32 v28, v28, v20, vcc
    v_lshlrev_b32 v20, 3, v24
    v_add_u32 v21, 92160, v20
    v_add_u32 v20, 33088, v20
    v_lshlrev_b32 v23, 4, v24
    v_add_u32 v23, 28928, v23
    v_cndmask_b32 v20, v20, v23, vcc
    v_cmp_eq_u32 vcc, 0, v4
    s_add_u32 s57, s64, 262144
    v_mov_b32 v212, v12
    v_mov_b32 v213, v13
    v_mov_b32 v214, 0
    v_mov_b32 v215, 0
    v_mov_b32 v216, v14
    v_mov_b32 v217, v15
    v_mov_b32 v218, 0
    v_mov_b32 v219, 0
    s_mov_b32 exec_lo, 0xffff0000
    s_mov_b32 exec_hi, 0
    buffer_store_dwordx2 v[12:13], v28, s[32:35], s64 offen offset:0 sc1
    buffer_store_dwordx2 v[14:15], v28, s[32:35], s57 offen offset:0 sc1
    s_mov_b32 exec_lo, 0
    s_mov_b32 exec_hi, 0xffff
    buffer_store_dwordx4 v[212:215], v28, s[32:35], s64 offen offset:0 sc1
    buffer_store_dwordx4 v[216:219], v28, s[32:35], s57 offen offset:0 sc1
    s_mov_b64 exec, -1
    v_add_u32 v23, 34112, v20
    v_cndmask_b32 v20, v20, v21, vcc
    v_add_u32 v21, 5120, v21
    v_cndmask_b32 v21, v23, v21, vcc
    s_barrier
    ds_write_b128 v27, v[220:223] offset:4096
    ds_write_b128 v27, v[224:227] offset:16512
    s_mov_b32 exec_hi, 0xffff
    ds_write_b64 v20, v[12:13]
    ds_write_b64 v21, v[14:15]
    s_mov_b32 exec_hi, -1
    s_lshr_b32 s48, s10, 1
    s_lshl_b32 s48, s48, 4
    s_add_u32 s48, s48, s25
    s_lshl_b32 s48, s48, 12
    s_add_u32 s48, s48, 0x750000
    s_lshl_b32 s50, s24, 7
    s_add_u32 s50, s50, s48
    s_add_u32 s49, s50, 128
    s_cmp_eq_u32 s24, 1
    s_cselect_b32 s51, 8, 16
    s_lshl_b32 s56, s24, 7
    s_sub_u32 s56, s56, 256
    s_lshl_b32 s54, s27, 6
    s_add_u32 s56, s56, s54
    s_lshl_b32 s58, s28, 18
    s_add_u32 s58, s58, s64
    s_lshl_b32 s52, s56, 4
    s_add_u32 s52, s52, s58
    s_lshl_b32 s53, s56, 3
    s_add_u32 s53, s53, s58
    s_add_u32 s53, s53, 245760
    s_cmp_lt_i32 s56, 0
    s_cselect_b32 s52, 0x40000000, s52
    s_cselect_b32 s53, 0x40000000, s53
    s_mul_i32 s65, s28, 34112
    s_lshl_b32 s54, s27, 10
    s_add_u32 s54, s54, s65
    s_mov_b32 s3, s65
    s_mov_b32 s30, s64
    s_waitcnt lgkmcnt(0)
    ds_read_b128 v[104:107], v7 offset:0
    ds_read_b128 v[108:111], v7 offset:1024
    ds_read_b128 v[112:115], v7 offset:2048
    ds_read_b128 v[116:119], v7 offset:3072
    ds_read_b128 v[120:123], v7 offset:4096
    ds_read_b128 v[124:127], v7 offset:5120
    ds_read_b128 v[128:131], v7 offset:6144
    ds_read_b128 v[132:135], v7 offset:7168
    s_lshl_b32 s56, s26, 11
    s_add_u32 s56, s56, 71680
    v_add_u32 v14, s56, v5
    s_xor_b32 s56, s26, 4
    s_lshl_b32 s56, s56, 11
    s_add_u32 s56, s56, 71680
    v_add_u32 v15, s56, v5
    ds_read_b128 v[136:139], v7 offset:8192
    ds_read_b128 v[140:143], v7 offset:9216
    s_waitcnt lgkmcnt(8)
    v_mfma_f32_16x16x32_bf16 v[240:243], v[104:107], v[68:71], 0
    v_mfma_f32_16x16x32_bf16 v[244:247], v[108:111], v[68:71], 0
    v_mfma_f32_16x16x32_bf16 v[232:235], v[104:107], v[32:35], 0
    v_mfma_f32_16x16x32_bf16 v[236:239], v[108:111], v[32:35], 0
    ds_read_b128 v[144:147], v7 offset:10240
    ds_read_b128 v[148:151], v7 offset:11264
    s_waitcnt lgkmcnt(8)
    v_mfma_f32_16x16x32_bf16 v[240:243], v[112:115], v[72:75], v[240:243]
    v_mfma_f32_16x16x32_bf16 v[244:247], v[116:119], v[72:75], v[244:247]
    v_mfma_f32_16x16x32_bf16 v[232:235], v[112:115], v[36:39], v[232:235]
    v_mfma_f32_16x16x32_bf16 v[236:239], v[116:119], v[36:39], v[236:239]
    ds_read_b128 v[172:175], v7 offset:12288
    ds_read_b128 v[176:179], v7 offset:13312
    s_waitcnt lgkmcnt(8)
    v_mfma_f32_16x16x32_bf16 v[240:243], v[120:123], v[76:79], v[240:243]
    v_mfma_f32_16x16x32_bf16 v[244:247], v[124:127], v[76:79], v[244:247]
    v_mfma_f32_16x16x32_bf16 v[232:235], v[120:123], v[40:43], v[232:235]
    v_mfma_f32_16x16x32_bf16 v[236:239], v[124:127], v[40:43], v[236:239]
    ds_read_b128 v[180:183], v7 offset:14336
    ds_read_b128 v[184:187], v7 offset:15360
    s_waitcnt lgkmcnt(8)
    v_mfma_f32_16x16x32_bf16 v[240:243], v[128:131], v[80:83], v[240:243]
    v_mfma_f32_16x16x32_bf16 v[244:247], v[132:135], v[80:83], v[244:247]
    v_mfma_f32_16x16x32_bf16 v[232:235], v[128:131], v[44:47], v[232:235]
    v_mfma_f32_16x16x32_bf16 v[236:239], v[132:135], v[44:47], v[236:239]
    ds_read_b128 v[188:191], v7 offset:16384
    ds_read_b128 v[212:215], v7 offset:17408
    s_waitcnt lgkmcnt(8)
    v_mfma_f32_16x16x32_bf16 v[240:243], v[136:139], v[84:87], v[240:243]
    v_mfma_f32_16x16x32_bf16 v[244:247], v[140:143], v[84:87], v[244:247]
    v_mfma_f32_16x16x32_bf16 v[232:235], v[136:139], v[48:51], v[232:235]
    v_mfma_f32_16x16x32_bf16 v[236:239], v[140:143], v[48:51], v[236:239]
    s_waitcnt lgkmcnt(6)
    v_mfma_f32_16x16x32_bf16 v[240:243], v[144:147], v[88:91], v[240:243]
    v_mfma_f32_16x16x32_bf16 v[244:247], v[148:151], v[88:91], v[244:247]
    v_mfma_f32_16x16x32_bf16 v[232:235], v[144:147], v[52:55], v[232:235]
    v_mfma_f32_16x16x32_bf16 v[236:239], v[148:151], v[52:55], v[236:239]
    s_waitcnt vmcnt(0)
    v_lshlrev_b32 v29, 7, v1
    v_mov_b32 v30, 1
    s_mov_b64 exec, 0x3
    buffer_atomic_add v30, v29, s[32:35], s49 offen sc1
    s_mov_b64 exec, -1
    s_waitcnt lgkmcnt(4)
    v_mfma_f32_16x16x32_bf16 v[240:243], v[172:175], v[92:95], v[240:243]
    v_mfma_f32_16x16x32_bf16 v[244:247], v[176:179], v[92:95], v[244:247]
    v_mfma_f32_16x16x32_bf16 v[232:235], v[172:175], v[56:59], v[232:235]
    v_mfma_f32_16x16x32_bf16 v[236:239], v[176:179], v[56:59], v[236:239]
    s_waitcnt lgkmcnt(2)
    v_mfma_f32_16x16x32_bf16 v[240:243], v[180:183], v[96:99], v[240:243]
    v_mfma_f32_16x16x32_bf16 v[244:247], v[184:187], v[96:99], v[244:247]
    v_mfma_f32_16x16x32_bf16 v[232:235], v[180:183], v[60:63], v[232:235]
    v_mfma_f32_16x16x32_bf16 v[236:239], v[184:187], v[60:63], v[236:239]
    s_waitcnt lgkmcnt(0)
    v_mfma_f32_16x16x32_bf16 v[240:243], v[188:191], v[100:103], v[240:243]
    v_mfma_f32_16x16x32_bf16 v[244:247], v[212:215], v[100:103], v[244:247]
    v_mfma_f32_16x16x32_bf16 v[232:235], v[188:191], v[64:67], v[232:235]
    v_mfma_f32_16x16x32_bf16 v[236:239], v[212:215], v[64:67], v[236:239]
    s_nop 5
    ds_write_b128 v14, v[240:243] offset:0
    ds_write_b128 v14, v[244:247] offset:1024
    s_waitcnt lgkmcnt(0)
    s_barrier
    ds_read_b128 v[240:243], v15 offset:0
    ds_read_b128 v[244:247], v15 offset:1024
    s_waitcnt lgkmcnt(0)
    v_pk_add_f32 v[232:233], v[232:233], v[240:241]
    v_pk_add_f32 v[234:235], v[234:235], v[242:243]
    v_pk_add_f32 v[236:237], v[236:237], v[244:245]
    v_pk_add_f32 v[238:239], v[238:239], v[246:247]
    v_pk_fma_f32 v[232:233], v[248:249], v[18:19], v[232:233] op_sel_hi:[1,0,1] neg_lo:[0,1,0] neg_hi:[0,1,0]
    v_pk_fma_f32 v[234:235], v[250:251], v[18:19], v[234:235] op_sel_hi:[1,0,1] neg_lo:[0,1,0] neg_hi:[0,1,0]
    v_pk_mul_f32 v[232:233], v[232:233], v[16:17] op_sel_hi:[1,0]
    v_pk_mul_f32 v[234:235], v[234:235], v[16:17] op_sel_hi:[1,0]
    v_cvt_pk_bf16_f32 v104, v232, v233
    v_cvt_pk_bf16_f32 v105, v234, v235
    v_pk_fma_f32 v[236:237], v[252:253], v[18:19], v[236:237] op_sel_hi:[1,0,1] neg_lo:[0,1,0] neg_hi:[0,1,0]
    v_pk_fma_f32 v[238:239], v[254:255], v[18:19], v[238:239] op_sel_hi:[1,0,1] neg_lo:[0,1,0] neg_hi:[0,1,0]
    v_pk_mul_f32 v[236:237], v[236:237], v[16:17] op_sel_hi:[1,0]
    v_pk_mul_f32 v[238:239], v[238:239], v[16:17] op_sel_hi:[1,0]
    v_cvt_pk_bf16_f32 v106, v236, v237
    v_cvt_pk_bf16_f32 v107, v238, v239
    s_nop 0
    v_permlane16_swap_b32 v104, v106
    v_permlane16_swap_b32 v105, v107
    ds_write_b128 v9, v[104:107]
    s_cmp_lg_u32 s26, 0
    s_cbranch_scc1 pl3_e
    s_cmp_eq_u32 s24, 0
    s_cbranch_scc1 pl3_e
    v_mov_b32 v29, 0
    s_mov_b64 exec, 1
    s_mov_b32 s90, 0
pl3:
    buffer_load_dword v27, v29, s[32:35], s50 offen sc1
    s_waitcnt vmcnt(0)
    v_readfirstlane_b32 s91, v27
    s_add_u32 s90, s90, 1
    s_cmp_ge_u32 s90, 200000
    s_cbranch_scc1 pl3_d
    s_cmp_lt_u32 s91, s51
    s_cbranch_scc1 pl3
pl3_d:
    s_mov_b64 exec, -1
pl3_e:
    s_waitcnt lgkmcnt(0)
    s_barrier
    s_add_u32 m0, s54, 0
    s_add_u32 s55, s52, 65536
    buffer_load_dwordx4 v5, s[32:35], s55 offen offset:0  lds
    s_add_u32 m0, s54, 6208
    s_add_u32 s55, s52, 98304
    buffer_load_dwordx4 v5, s[32:35], s55 offen offset:0  lds
    s_lshl_b32 s55, s27, 9
    s_add_u32 s55, s55, s3
    s_add_u32 m0, s55, 31040
    s_mov_b32 exec_hi, 0
    buffer_load_dwordx4 v5, s[32:35], s53 offen offset:0  lds
    s_mov_b32 exec_hi, -1
    s_add_u32 m0, s54, 12416
    s_add_u32 s55, s52, 131072
    buffer_load_dwordx4 v5, s[32:35], s55 offen offset:0  lds
    s_add_u32 m0, s54, 18624
    s_add_u32 s55, s52, 163840
    buffer_load_dwordx4 v5, s[32:35], s55 offen offset:0  lds
    s_add_u32 m0, s54, 24832
    s_add_u32 s55, s52, 196608
    buffer_load_dwordx4 v5, s[32:35], s55 offen offset:0  lds
    v_and_b32 v3, 31, v1
    v_lshrrev_b32 v4, 5, v1
    s_lshl_b32 s27, s27, 5
    v_add_u32 v9, s27, v3
    v_lshlrev_b32 v10, 4, v9
    v_add_u32 v21, s65, v10
    s_mul_i32 s29, s28, 5120
    s_add_u32 s29, s29, 88064
    v_lshl_add_u32 v10, v4, 11, v10
    v_add_u32 v10, s29, v10
    v_lshlrev_b32 v20, 3, v9
    v_add_u32 v8, s29, v20
    v_add_u32 v20, s65, v20
    v_mov_b32 v16, 0
    v_mov_b32 v17, 0
    v_mov_b32 v18, 0
    v_mov_b32 v19, 0
    v_mul_u32_u24 v9, 6208, v4
    v_add_u32 v21, v21, v9
    v_add_u32 v20, 31040, v20
    v_mov_b32 v230, 0
    v_mov_b32 v231, 0
    v_mov_b32 v238, 0
    v_mov_b32 v239, 0
    v_mov_b32 v246, 0
    v_mov_b32 v247, 0
    v_bfe_u32 v22, v1, 2, 2
    v_lshl_add_u32 v22, v4, 2, v22
    v_add_u32 v22, s27, v22
    v_lshlrev_b32 v22, 4, v22
    v_bfe_u32 v23, v1, 1, 1
    v_mul_u32_u24 v23, 6208, v23
    v_and_b32 v25, 1, v1
    v_lshl_add_u32 v23, v25, 3, v23
    v_and_b32 v25, 16, v1
    v_cmp_eq_u32 vcc, 0, v25
    v_mov_b32 v25, 12416
    s_add_u32 s65, s65, 12416
    v_cndmask_b32 v23, v25, v23, vcc
    v_add3_u32 v22, v22, v23, s65
    s_lshr_b32 s27, s27, 5
    s_lshl_b32 s40, s24, 2
    s_add_u32 s40, s40, s27
    s_lshl_b32 s41, s25, 1
    s_add_u32 s41, s41, s28
    s_mul_i32 s42, s10, 0x240000
    s_mul_i32 s45, s40, 36864
    s_add_u32 s45, s45, s42
    s_add_u32 s45, s45, 0x3000000
    s_lshl_b32 s42, s41, 10
    s_and_b32 s43, s41, 1
    s_lshl_b32 s43, s43, 9
    s_sub_u32 s42, s42, s43
    s_add_u32 s44, s45, s42
    s_lshl_b32 s42, s41, 7
    s_add_u32 s45, s45, s42
    s_add_u32 s45, s45, 32768
    s_sub_u32 s42, 8, s40
    s_max_i32 s42, s42, 0
    v_lshlrev_b32 v11, 2, v4
    v_sub_u32 v11, v3, v11
    v_cmp_gt_i32 s[56:57], 0, v11
    v_cmp_gt_i32 s[58:59], 1, v11
    v_cmp_gt_i32 s[60:61], 2, v11
    v_cmp_gt_i32 s[62:63], 3, v11
    v_cmp_gt_i32 s[64:65], 8, v11
    v_cmp_gt_i32 s[66:67], 9, v11
    v_cmp_gt_i32 s[68:69], 10, v11
    v_cmp_gt_i32 s[70:71], 11, v11
    v_cmp_gt_i32 s[72:73], 16, v11
    v_cmp_gt_i32 s[74:75], 17, v11
    v_cmp_gt_i32 s[76:77], 18, v11
    v_cmp_gt_i32 s[78:79], 19, v11
    v_cmp_gt_i32 s[80:81], 24, v11
    v_cmp_gt_i32 s[82:83], 25, v11
    v_cmp_gt_i32 s[84:85], 26, v11
    v_cmp_gt_i32 s[86:87], 27, v11
    v_mov_b32 v26, 0xffff
    v_mov_b32 v27, 0xffff0000
    v_cndmask_b32 v36, 0, v26, s[56:57]
    v_cndmask_b32 v25, 0, v27, s[58:59]
    v_or_b32 v36, v36, v25
    v_cndmask_b32 v37, 0, v26, s[60:61]
    v_cndmask_b32 v25, 0, v27, s[62:63]
    v_or_b32 v37, v37, v25
    v_cndmask_b32 v38, 0, v26, s[64:65]
    v_cndmask_b32 v25, 0, v27, s[66:67]
    v_or_b32 v38, v38, v25
    v_cndmask_b32 v39, 0, v26, s[68:69]
    v_cndmask_b32 v25, 0, v27, s[70:71]
    v_or_b32 v39, v39, v25
    v_cndmask_b32 v40, 0, v26, s[72:73]
    v_cndmask_b32 v25, 0, v27, s[74:75]
    v_or_b32 v40, v40, v25
    v_cndmask_b32 v41, 0, v26, s[76:77]
    v_cndmask_b32 v25, 0, v27, s[78:79]
    v_or_b32 v41, v41, v25
    v_cndmask_b32 v42, 0, v26, s[80:81]
    v_cndmask_b32 v25, 0, v27, s[82:83]
    v_or_b32 v42, v42, v25
    v_cndmask_b32 v43, 0, v26, s[84:85]
    v_cndmask_b32 v25, 0, v27, s[86:87]
    v_or_b32 v43, v43, v25
    v_mov_b32 v24, 0xf149f2ca
    s_mov_b32 s46, 0x3eae1a93
    ds_read_b128 v[12:15], v10
    s_mov_b32 exec_hi, 0
    ds_read_b64 v[16:17], v8 offset:4096
    s_mov_b32 exec_hi, -1
    s_waitcnt vmcnt(0) lgkmcnt(0)
    s_barrier
    ds_read_b128 v[224:227], v21 offset:0
    ds_read_b64 v[228:229], v20 offset:0
    ds_read_b128 v[232:235], v21 offset:512
    ds_read_b64 v[236:237], v20 offset:256
    ds_read_b128 v[240:243], v21 offset:1024
    ds_read_b64 v[244:245], v20 offset:512
    s_waitcnt lgkmcnt(4)
    v_mfma_f32_32x32x16_bf16 v[64:79], v[224:227], v[12:15], 0
    v_mfma_f32_32x32x16_bf16 v[64:79], v[228:231], v[16:19], v[64:79]
    ds_read_b128 v[224:227], v21 offset:1536
    ds_read_b64 v[228:229], v20 offset:768
    s_waitcnt lgkmcnt(4)
    v_mfma_f32_32x32x16_bf16 v[80:95], v[232:235], v[12:15], 0
    v_mfma_f32_32x32x16_bf16 v[80:95], v[236:239], v[16:19], v[80:95]
    ds_read_b128 v[232:235], v21 offset:2048
    ds_read_b64 v[236:237], v20 offset:1024
    s_waitcnt lgkmcnt(4)
    v_mfma_f32_32x32x16_bf16 v[96:111], v[240:243], v[12:15], 0
    v_mfma_f32_32x32x16_bf16 v[96:111], v[244:247], v[16:19], v[96:111]
    ds_read_b128 v[240:243], v21 offset:2560
    ds_read_b64 v[244:245], v20 offset:1280
    s_waitcnt lgkmcnt(4)
    v_mfma_f32_32x32x16_bf16 v[112:127], v[224:227], v[12:15], 0
    s_cmp_le_u32 s42, 0
    s_cbranch_scc1 attn_ok0
    v_mov_b32 v64, v24
    v_mov_b32 v65, v24
    v_mov_b32 v66, v24
    v_mov_b32 v67, v24
    v_mov_b32 v68, v24
    v_mov_b32 v69, v24
    v_mov_b32 v70, v24
    v_mov_b32 v71, v24
    v_mov_b32 v72, v24
    v_mov_b32 v73, v24
    v_mov_b32 v74, v24
    v_mov_b32 v75, v24
    v_mov_b32 v76, v24
    v_mov_b32 v77, v24
    v_mov_b32 v78, v24
    v_mov_b32 v79, v24
attn_ok0:
    v_mfma_f32_32x32x16_bf16 v[112:127], v[228:231], v[16:19], v[112:127]
    ds_read_b128 v[224:227], v21 offset:3072
    ds_read_b64 v[228:229], v20 offset:1536
    s_waitcnt lgkmcnt(4)
    v_mfma_f32_32x32x16_bf16 v[128:143], v[232:235], v[12:15], 0
    s_cmp_le_u32 s42, 1
    s_cbranch_scc1 attn_ok1
    v_mov_b32 v80, v24
    v_mov_b32 v81, v24
    v_mov_b32 v82, v24
    v_mov_b32 v83, v24
    v_mov_b32 v84, v24
    v_mov_b32 v85, v24
    v_mov_b32 v86, v24
    v_mov_b32 v87, v24
    v_mov_b32 v88, v24
    v_mov_b32 v89, v24
    v_mov_b32 v90, v24
    v_mov_b32 v91, v24
    v_mov_b32 v92, v24
    v_mov_b32 v93, v24
    v_mov_b32 v94, v24
    v_mov_b32 v95, v24
attn_ok1:
    v_max_f32 v25, v80, v81
    v_max_f32 v26, v82, v83
    v_max3_f32 v25, v25, v84, v85
    v_max3_f32 v26, v26, v86, v87
    v_mfma_f32_32x32x16_bf16 v[128:143], v[236:239], v[16:19], v[128:143]
    v_max3_f32 v25, v25, v88, v89
    v_max3_f32 v26, v26, v90, v91
    v_max3_f32 v25, v25, v92, v93
    v_max3_f32 v26, v26, v94, v95
    ds_read_b128 v[232:235], v21 offset:3584
    ds_read_b64 v[236:237], v20 offset:1792
    s_waitcnt lgkmcnt(4)
    v_mfma_f32_32x32x16_bf16 v[144:159], v[240:243], v[12:15], 0
    s_cmp_le_u32 s42, 2
    s_cbranch_scc1 attn_ok2
    v_mov_b32 v96, v24
    v_mov_b32 v97, v24
    v_mov_b32 v98, v24
    v_mov_b32 v99, v24
    v_mov_b32 v100, v24
    v_mov_b32 v101, v24
    v_mov_b32 v102, v24
    v_mov_b32 v103, v24
    v_mov_b32 v104, v24
    v_mov_b32 v105, v24
    v_mov_b32 v106, v24
    v_mov_b32 v107, v24
    v_mov_b32 v108, v24
    v_mov_b32 v109, v24
    v_mov_b32 v110, v24
    v_mov_b32 v111, v24
attn_ok2:
    v_max3_f32 v25, v25, v96, v97
    v_max3_f32 v26, v26, v98, v99
    v_max3_f32 v25, v25, v100, v101
    v_max3_f32 v26, v26, v102, v103
    v_mfma_f32_32x32x16_bf16 v[144:159], v[244:247], v[16:19], v[144:159]
    v_max3_f32 v25, v25, v104, v105
    v_max3_f32 v26, v26, v106, v107
    v_max3_f32 v25, v25, v108, v109
    v_max3_f32 v26, v26, v110, v111
    ds_read_b128 v[240:243], v21 offset:4096
    ds_read_b64 v[244:245], v20 offset:2048
    s_waitcnt lgkmcnt(4)
    v_mfma_f32_32x32x16_bf16 v[160:175], v[224:227], v[12:15], 0
    s_cmp_le_u32 s42, 3
    s_cbranch_scc1 attn_ok3
    v_mov_b32 v112, v24
    v_mov_b32 v113, v24
    v_mov_b32 v114, v24
    v_mov_b32 v115, v24
    v_mov_b32 v116, v24
    v_mov_b32 v117, v24
    v_mov_b32 v118, v24
    v_mov_b32 v119, v24
    v_mov_b32 v120, v24
    v_mov_b32 v121, v24
    v_mov_b32 v122, v24
    v_mov_b32 v123, v24
    v_mov_b32 v124, v24
    v_mov_b32 v125, v24
    v_mov_b32 v126, v24
    v_mov_b32 v127, v24
attn_ok3:
    v_max3_f32 v25, v25, v112, v113
    v_max3_f32 v26, v26, v114, v115
    v_max3_f32 v25, v25, v116, v117
    v_max3_f32 v26, v26, v118, v119
    v_mfma_f32_32x32x16_bf16 v[160:175], v[228:231], v[16:19], v[160:175]
    v_max3_f32 v25, v25, v120, v121
    v_max3_f32 v26, v26, v122, v123
    v_max3_f32 v25, v25, v124, v125
    v_max3_f32 v26, v26, v126, v127
    s_waitcnt lgkmcnt(2)
    v_mfma_f32_32x32x16_bf16 v[176:191], v[232:235], v[12:15], 0
    s_cmp_le_u32 s42, 4
    s_cbranch_scc1 attn_ok4
    v_mov_b32 v128, v24
    v_mov_b32 v129, v24
    v_mov_b32 v130, v24
    v_mov_b32 v131, v24
    v_mov_b32 v132, v24
    v_mov_b32 v133, v24
    v_mov_b32 v134, v24
    v_mov_b32 v135, v24
    v_mov_b32 v136, v24
    v_mov_b32 v137, v24
    v_mov_b32 v138, v24
    v_mov_b32 v139, v24
    v_mov_b32 v140, v24
    v_mov_b32 v141, v24
    v_mov_b32 v142, v24
    v_mov_b32 v143, v24
attn_ok4:
    v_max3_f32 v25, v25, v128, v129
    v_max3_f32 v26, v26, v130, v131
    v_max3_f32 v25, v25, v132, v133
    v_max3_f32 v26, v26, v134, v135
    v_mfma_f32_32x32x16_bf16 v[176:191], v[236:239], v[16:19], v[176:191]
    v_max3_f32 v25, v25, v136, v137
    v_max3_f32 v26, v26, v138, v139
    v_max3_f32 v25, v25, v140, v141
    v_max3_f32 v26, v26, v142, v143
    s_waitcnt lgkmcnt(0)
    v_mfma_f32_32x32x16_bf16 v[192:207], v[240:243], v[12:15], 0
    s_cmp_le_u32 s42, 5
    s_cbranch_scc1 attn_ok5
    v_mov_b32 v144, v24
    v_mov_b32 v145, v24
    v_mov_b32 v146, v24
    v_mov_b32 v147, v24
    v_mov_b32 v148, v24
    v_mov_b32 v149, v24
    v_mov_b32 v150, v24
    v_mov_b32 v151, v24
    v_mov_b32 v152, v24
    v_mov_b32 v153, v24
    v_mov_b32 v154, v24
    v_mov_b32 v155, v24
    v_mov_b32 v156, v24
    v_mov_b32 v157, v24
    v_mov_b32 v158, v24
    v_mov_b32 v159, v24
attn_ok5:
    v_max3_f32 v25, v25, v144, v145
    v_max3_f32 v26, v26, v146, v147
    v_max3_f32 v25, v25, v148, v149
    v_max3_f32 v26, v26, v150, v151
    v_mfma_f32_32x32x16_bf16 v[192:207], v[244:247], v[16:19], v[192:207]
    v_max3_f32 v25, v25, v152, v153
    v_max3_f32 v26, v26, v154, v155
    v_max3_f32 v25, v25, v156, v157
    v_max3_f32 v26, v26, v158, v159
    s_cmp_le_u32 s42, 6
    s_cbranch_scc1 attn_ok6
    v_mov_b32 v160, v24
    v_mov_b32 v161, v24
    v_mov_b32 v162, v24
    v_mov_b32 v163, v24
    v_mov_b32 v164, v24
    v_mov_b32 v165, v24
    v_mov_b32 v166, v24
    v_mov_b32 v167, v24
    v_mov_b32 v168, v24
    v_mov_b32 v169, v24
    v_mov_b32 v170, v24
    v_mov_b32 v171, v24
    v_mov_b32 v172, v24
    v_mov_b32 v173, v24
    v_mov_b32 v174, v24
    v_mov_b32 v175, v24
attn_ok6:
    v_max3_f32 v25, v25, v160, v161
    v_max3_f32 v26, v26, v162, v163
    v_max3_f32 v25, v25, v164, v165
    v_max3_f32 v26, v26, v166, v167
    v_max3_f32 v25, v25, v168, v169
    v_max3_f32 v26, v26, v170, v171
    v_max3_f32 v25, v25, v172, v173
    v_max3_f32 v26, v26, v174, v175
    s_cmp_le_u32 s42, 7
    s_cbranch_scc1 attn_ok7
    v_mov_b32 v176, v24
    v_mov_b32 v177, v24
    v_mov_b32 v178, v24
    v_mov_b32 v179, v24
    v_mov_b32 v180, v24
    v_mov_b32 v181, v24
    v_mov_b32 v182, v24
    v_mov_b32 v183, v24
    v_mov_b32 v184, v24
    v_mov_b32 v185, v24
    v_mov_b32 v186, v24
    v_mov_b32 v187, v24
    v_mov_b32 v188, v24
    v_mov_b32 v189, v24
    v_mov_b32 v190, v24
    v_mov_b32 v191, v24
attn_ok7:
    v_max3_f32 v25, v25, v176, v177
    v_max3_f32 v26, v26, v178, v179
    v_max3_f32 v25, v25, v180, v181
    v_max3_f32 v26, v26, v182, v183
    v_max3_f32 v25, v25, v184, v185
    v_max3_f32 v26, v26, v186, v187
    v_max3_f32 v25, v25, v188, v189
    v_max3_f32 v26, v26, v190, v191
    ds_read_b64_tr_b16 v[224:225], v22 offset:512
    ds_read_b64_tr_b16 v[226:227], v22 offset:640
    ds_read_b64_tr_b16 v[228:229], v22 offset:768
    ds_read_b64_tr_b16 v[230:231], v22 offset:896
    ds_read_b64_tr_b16 v[232:233], v22 offset:1024
    ds_read_b64_tr_b16 v[234:235], v22 offset:1152
    ds_read_b64_tr_b16 v[236:237], v22 offset:1280
    ds_read_b64_tr_b16 v[238:239], v22 offset:1408
    ds_read_b64_tr_b16 v[240:241], v22 offset:1536
    ds_read_b64_tr_b16 v[242:243], v22 offset:1664
    ds_read_b64_tr_b16 v[244:245], v22 offset:1792
    ds_read_b64_tr_b16 v[246:247], v22 offset:1920
    v_cndmask_b32 v64, v192, v64, s[56:57]
    v_cndmask_b32 v65, v193, v65, s[58:59]
    v_cndmask_b32 v66, v194, v66, s[60:61]
    v_cndmask_b32 v67, v195, v67, s[62:63]
    v_cndmask_b32 v68, v196, v68, s[64:65]
    v_cndmask_b32 v69, v197, v69, s[66:67]
    v_cndmask_b32 v70, v198, v70, s[68:69]
    v_cndmask_b32 v71, v199, v71, s[70:71]
    v_cndmask_b32 v72, v200, v72, s[72:73]
    v_cndmask_b32 v73, v201, v73, s[74:75]
    v_cndmask_b32 v74, v202, v74, s[76:77]
    v_cndmask_b32 v75, v203, v75, s[78:79]
    v_cndmask_b32 v76, v204, v76, s[80:81]
    v_cndmask_b32 v77, v205, v77, s[82:83]
    v_cndmask_b32 v78, v206, v78, s[84:85]
    v_cndmask_b32 v79, v207, v79, s[86:87]
    v_max3_f32 v25, v25, v64, v65
    v_max3_f32 v26, v26, v66, v67
    v_max3_f32 v25, v25, v68, v69
    v_max3_f32 v26, v26, v70, v71
    v_max3_f32 v25, v25, v72, v73
    v_max3_f32 v26, v26, v74, v75
    v_max3_f32 v25, v25, v76, v77
    v_max3_f32 v26, v26, v78, v79
    v_max_f32 v25, v25, v26
    v_mov_b32 v26, v25
    s_nop 1
    v_permlane32_swap_b32 v25, v26
    s_nop 0
    v_max_f32 v25, v25, v26
    v_mul_f32 v26, s46, v25
    v_pk_fma_f32 v[80:81], v[80:81], s[46:47], v[26:27] op_sel_hi:[1,0,0] neg_lo:[0,0,1] neg_hi:[0,0,1]
    v_pk_fma_f32 v[82:83], v[82:83], s[46:47], v[26:27] op_sel_hi:[1,0,0] neg_lo:[0,0,1] neg_hi:[0,0,1]
    v_pk_fma_f32 v[84:85], v[84:85], s[46:47], v[26:27] op_sel_hi:[1,0,0] neg_lo:[0,0,1] neg_hi:[0,0,1]
    v_pk_fma_f32 v[86:87], v[86:87], s[46:47], v[26:27] op_sel_hi:[1,0,0] neg_lo:[0,0,1] neg_hi:[0,0,1]
    v_pk_fma_f32 v[88:89], v[88:89], s[46:47], v[26:27] op_sel_hi:[1,0,0] neg_lo:[0,0,1] neg_hi:[0,0,1]
    v_pk_fma_f32 v[90:91], v[90:91], s[46:47], v[26:27] op_sel_hi:[1,0,0] neg_lo:[0,0,1] neg_hi:[0,0,1]
    v_pk_fma_f32 v[92:93], v[92:93], s[46:47], v[26:27] op_sel_hi:[1,0,0] neg_lo:[0,0,1] neg_hi:[0,0,1]
    v_pk_fma_f32 v[94:95], v[94:95], s[46:47], v[26:27] op_sel_hi:[1,0,0] neg_lo:[0,0,1] neg_hi:[0,0,1]
    v_exp_f32 v80, v80
    v_pk_fma_f32 v[96:97], v[96:97], s[46:47], v[26:27] op_sel_hi:[1,0,0] neg_lo:[0,0,1] neg_hi:[0,0,1]
    v_exp_f32 v81, v81
    v_exp_f32 v82, v82
    v_pk_fma_f32 v[98:99], v[98:99], s[46:47], v[26:27] op_sel_hi:[1,0,0] neg_lo:[0,0,1] neg_hi:[0,0,1]
    v_exp_f32 v83, v83
    v_cvt_pk_bf16_f32 v80, v80, v81
    s_lshl_b32 s31, s26, 10
    s_add_u32 m0, s31, 71680
    s_mul_i32 s29, s13, 92160
    s_add_u32 s31, s31, s29
    s_mul_i32 s29, s14, 0x100000
    s_add_u32 s31, s31, s29
    s_add_u32 s31, s31, 0x400000
    buffer_load_dwordx4 v5, s[32:35], s31 offen offset:0  lds
    v_exp_f32 v84, v84
    v_pk_fma_f32 v[100:101], v[100:101], s[46:47], v[26:27] op_sel_hi:[1,0,0] neg_lo:[0,0,1] neg_hi:[0,0,1]
    v_exp_f32 v85, v85
    v_cvt_pk_bf16_f32 v81, v82, v83
    v_exp_f32 v86, v86
    v_pk_fma_f32 v[102:103], v[102:103], s[46:47], v[26:27] op_sel_hi:[1,0,0] neg_lo:[0,0,1] neg_hi:[0,0,1]
    v_exp_f32 v87, v87
    v_cvt_pk_bf16_f32 v82, v84, v85
    v_exp_f32 v88, v88
    v_pk_fma_f32 v[104:105], v[104:105], s[46:47], v[26:27] op_sel_hi:[1,0,0] neg_lo:[0,0,1] neg_hi:[0,0,1]
    v_exp_f32 v89, v89
    v_cvt_pk_bf16_f32 v83, v86, v87
    s_add_u32 m0, m0, 8192
    s_add_u32 s31, s31, 8192
    buffer_load_dwordx4 v5, s[32:35], s31 offen offset:0  lds
    v_exp_f32 v90, v90
    v_pk_fma_f32 v[106:107], v[106:107], s[46:47], v[26:27] op_sel_hi:[1,0,0] neg_lo:[0,0,1] neg_hi:[0,0,1]
    v_exp_f32 v91, v91
    v_cvt_pk_bf16_f32 v84, v88, v89
    v_exp_f32 v92, v92
    v_pk_fma_f32 v[108:109], v[108:109], s[46:47], v[26:27] op_sel_hi:[1,0,0] neg_lo:[0,0,1] neg_hi:[0,0,1]
    s_waitcnt lgkmcnt(8)
    v_mfma_f32_32x32x16_bf16 v[208:223], v[224:227], v[80:83], 0
    v_exp_f32 v93, v93
    v_cvt_pk_bf16_f32 v85, v90, v91
    v_exp_f32 v94, v94
    v_pk_fma_f32 v[110:111], v[110:111], s[46:47], v[26:27] op_sel_hi:[1,0,0] neg_lo:[0,0,1] neg_hi:[0,0,1]
    v_exp_f32 v95, v95
    v_cvt_pk_bf16_f32 v86, v92, v93
    s_nop 0
    v_cvt_pk_bf16_f32 v87, v94, v95
    v_exp_f32 v96, v96
    v_pk_fma_f32 v[112:113], v[112:113], s[46:47], v[26:27] op_sel_hi:[1,0,0] neg_lo:[0,0,1] neg_hi:[0,0,1]
    v_exp_f32 v97, v97
    v_exp_f32 v98, v98
    v_pk_fma_f32 v[114:115], v[114:115], s[46:47], v[26:27] op_sel_hi:[1,0,0] neg_lo:[0,0,1] neg_hi:[0,0,1]
    v_mfma_f32_32x32x16_bf16 v[208:223], v[228:231], v[84:87], v[208:223]
    ds_read_b64_tr_b16 v[248:249], v22 offset:2048
    ds_read_b64_tr_b16 v[250:251], v22 offset:2176
    ds_read_b64_tr_b16 v[252:253], v22 offset:2304
    ds_read_b64_tr_b16 v[254:255], v22 offset:2432
    v_exp_f32 v99, v99
    v_cvt_pk_bf16_f32 v96, v96, v97
    s_add_u32 m0, m0, 8192
    s_add_u32 s31, s31, 8192
    buffer_load_dwordx4 v5, s[32:35], s31 offen offset:0  lds
    v_exp_f32 v100, v100
    v_pk_fma_f32 v[116:117], v[116:117], s[46:47], v[26:27] op_sel_hi:[1,0,0] neg_lo:[0,0,1] neg_hi:[0,0,1]
    v_exp_f32 v101, v101
    v_cvt_pk_bf16_f32 v97, v98, v99
    v_exp_f32 v102, v102
    v_pk_fma_f32 v[118:119], v[118:119], s[46:47], v[26:27] op_sel_hi:[1,0,0] neg_lo:[0,0,1] neg_hi:[0,0,1]
    v_exp_f32 v103, v103
    v_cvt_pk_bf16_f32 v98, v100, v101
    v_exp_f32 v104, v104
    v_pk_fma_f32 v[120:121], v[120:121], s[46:47], v[26:27] op_sel_hi:[1,0,0] neg_lo:[0,0,1] neg_hi:[0,0,1]
    v_exp_f32 v105, v105
    v_cvt_pk_bf16_f32 v99, v102, v103
    s_add_u32 m0, m0, 8192
    s_add_u32 s31, s31, 8192
    buffer_load_dwordx4 v5, s[32:35], s31 offen offset:0  lds
    v_exp_f32 v106, v106
    v_pk_fma_f32 v[122:123], v[122:123], s[46:47], v[26:27] op_sel_hi:[1,0,0] neg_lo:[0,0,1] neg_hi:[0,0,1]
    v_exp_f32 v107, v107
    v_cvt_pk_bf16_f32 v100, v104, v105
    v_exp_f32 v108, v108
    v_pk_fma_f32 v[124:125], v[124:125], s[46:47], v[26:27] op_sel_hi:[1,0,0] neg_lo:[0,0,1] neg_hi:[0,0,1]
    s_waitcnt lgkmcnt(8)
    v_mfma_f32_32x32x16_bf16 v[208:223], v[232:235], v[96:99], v[208:223]
    v_exp_f32 v109, v109
    v_cvt_pk_bf16_f32 v101, v106, v107
    v_exp_f32 v110, v110
    v_pk_fma_f32 v[126:127], v[126:127], s[46:47], v[26:27] op_sel_hi:[1,0,0] neg_lo:[0,0,1] neg_hi:[0,0,1]
    v_exp_f32 v111, v111
    v_cvt_pk_bf16_f32 v102, v108, v109
    s_nop 0
    v_cvt_pk_bf16_f32 v103, v110, v111
    v_exp_f32 v112, v112
    v_pk_fma_f32 v[128:129], v[128:129], s[46:47], v[26:27] op_sel_hi:[1,0,0] neg_lo:[0,0,1] neg_hi:[0,0,1]
    v_exp_f32 v113, v113
    v_exp_f32 v114, v114
    v_pk_fma_f32 v[130:131], v[130:131], s[46:47], v[26:27] op_sel_hi:[1,0,0] neg_lo:[0,0,1] neg_hi:[0,0,1]
    v_mfma_f32_32x32x16_bf16 v[208:223], v[236:239], v[100:103], v[208:223]
    ds_read_b64_tr_b16 v[224:225], v22 offset:2560
    ds_read_b64_tr_b16 v[226:227], v22 offset:2688
    ds_read_b64_tr_b16 v[228:229], v22 offset:2816
    ds_read_b64_tr_b16 v[230:231], v22 offset:2944
    v_exp_f32 v115, v115
    v_cvt_pk_bf16_f32 v112, v112, v113
    s_add_u32 m0, m0, 8192
    s_add_u32 s31, s31, 8192
    buffer_load_dwordx4 v5, s[32:35], s31 offen offset:0  lds
    v_exp_f32 v116, v116
    v_pk_fma_f32 v[132:133], v[132:133], s[46:47], v[26:27] op_sel_hi:[1,0,0] neg_lo:[0,0,1] neg_hi:[0,0,1]
    v_exp_f32 v117, v117
    v_cvt_pk_bf16_f32 v113, v114, v115
    v_exp_f32 v118, v118
    v_pk_fma_f32 v[134:135], v[134:135], s[46:47], v[26:27] op_sel_hi:[1,0,0] neg_lo:[0,0,1] neg_hi:[0,0,1]
    v_exp_f32 v119, v119
    v_cvt_pk_bf16_f32 v114, v116, v117
    v_exp_f32 v120, v120
    v_pk_fma_f32 v[136:137], v[136:137], s[46:47], v[26:27] op_sel_hi:[1,0,0] neg_lo:[0,0,1] neg_hi:[0,0,1]
    v_exp_f32 v121, v121
    v_cvt_pk_bf16_f32 v115, v118, v119
    s_add_u32 m0, m0, 8192
    s_add_u32 s31, s31, 8192
    buffer_load_dwordx4 v5, s[32:35], s31 offen offset:0  lds
    v_exp_f32 v122, v122
    v_pk_fma_f32 v[138:139], v[138:139], s[46:47], v[26:27] op_sel_hi:[1,0,0] neg_lo:[0,0,1] neg_hi:[0,0,1]
    v_exp_f32 v123, v123
    v_cvt_pk_bf16_f32 v116, v120, v121
    v_exp_f32 v124, v124
    v_pk_fma_f32 v[140:141], v[140:141], s[46:47], v[26:27] op_sel_hi:[1,0,0] neg_lo:[0,0,1] neg_hi:[0,0,1]
    s_waitcnt lgkmcnt(8)
    v_mfma_f32_32x32x16_bf16 v[208:223], v[240:243], v[112:115], v[208:223]
    v_exp_f32 v125, v125
    v_cvt_pk_bf16_f32 v117, v122, v123
    v_exp_f32 v126, v126
    v_pk_fma_f32 v[142:143], v[142:143], s[46:47], v[26:27] op_sel_hi:[1,0,0] neg_lo:[0,0,1] neg_hi:[0,0,1]
    v_exp_f32 v127, v127
    v_cvt_pk_bf16_f32 v118, v124, v125
    s_nop 0
    v_cvt_pk_bf16_f32 v119, v126, v127
    v_exp_f32 v128, v128
    v_pk_fma_f32 v[144:145], v[144:145], s[46:47], v[26:27] op_sel_hi:[1,0,0] neg_lo:[0,0,1] neg_hi:[0,0,1]
    v_exp_f32 v129, v129
    v_exp_f32 v130, v130
    v_pk_fma_f32 v[146:147], v[146:147], s[46:47], v[26:27] op_sel_hi:[1,0,0] neg_lo:[0,0,1] neg_hi:[0,0,1]
    v_mfma_f32_32x32x16_bf16 v[208:223], v[244:247], v[116:119], v[208:223]
    ds_read_b64_tr_b16 v[232:233], v22 offset:3072
    ds_read_b64_tr_b16 v[234:235], v22 offset:3200
    ds_read_b64_tr_b16 v[236:237], v22 offset:3328
    ds_read_b64_tr_b16 v[238:239], v22 offset:3456
    v_exp_f32 v131, v131
    v_cvt_pk_bf16_f32 v128, v128, v129
    s_add_u32 m0, m0, 8192
    s_add_u32 s31, s31, 8192
    buffer_load_dwordx4 v5, s[32:35], s31 offen offset:0  lds
    v_exp_f32 v132, v132
    v_pk_fma_f32 v[148:149], v[148:149], s[46:47], v[26:27] op_sel_hi:[1,0,0] neg_lo:[0,0,1] neg_hi:[0,0,1]
    v_exp_f32 v133, v133
    v_cvt_pk_bf16_f32 v129, v130, v131
    v_exp_f32 v134, v134
    v_pk_fma_f32 v[150:151], v[150:151], s[46:47], v[26:27] op_sel_hi:[1,0,0] neg_lo:[0,0,1] neg_hi:[0,0,1]
    v_exp_f32 v135, v135
    v_cvt_pk_bf16_f32 v130, v132, v133
    v_exp_f32 v136, v136
    v_pk_fma_f32 v[152:153], v[152:153], s[46:47], v[26:27] op_sel_hi:[1,0,0] neg_lo:[0,0,1] neg_hi:[0,0,1]
    v_exp_f32 v137, v137
    v_cvt_pk_bf16_f32 v131, v134, v135
    s_add_u32 m0, m0, 8192
    s_add_u32 s31, s31, 8192
    buffer_load_dwordx4 v5, s[32:35], s31 offen offset:0  lds
    v_exp_f32 v138, v138
    v_pk_fma_f32 v[154:155], v[154:155], s[46:47], v[26:27] op_sel_hi:[1,0,0] neg_lo:[0,0,1] neg_hi:[0,0,1]
    v_exp_f32 v139, v139
    v_cvt_pk_bf16_f32 v132, v136, v137
    v_exp_f32 v140, v140
    v_pk_fma_f32 v[156:157], v[156:157], s[46:47], v[26:27] op_sel_hi:[1,0,0] neg_lo:[0,0,1] neg_hi:[0,0,1]
    s_waitcnt lgkmcnt(8)
    v_mfma_f32_32x32x16_bf16 v[208:223], v[248:251], v[128:131], v[208:223]
    v_exp_f32 v141, v141
    v_cvt_pk_bf16_f32 v133, v138, v139
    v_exp_f32 v142, v142
    v_pk_fma_f32 v[158:159], v[158:159], s[46:47], v[26:27] op_sel_hi:[1,0,0] neg_lo:[0,0,1] neg_hi:[0,0,1]
    v_exp_f32 v143, v143
    v_cvt_pk_bf16_f32 v134, v140, v141
    s_nop 0
    v_cvt_pk_bf16_f32 v135, v142, v143
    v_exp_f32 v144, v144
    v_pk_fma_f32 v[160:161], v[160:161], s[46:47], v[26:27] op_sel_hi:[1,0,0] neg_lo:[0,0,1] neg_hi:[0,0,1]
    v_exp_f32 v145, v145
    v_exp_f32 v146, v146
    v_pk_fma_f32 v[162:163], v[162:163], s[46:47], v[26:27] op_sel_hi:[1,0,0] neg_lo:[0,0,1] neg_hi:[0,0,1]
    v_mfma_f32_32x32x16_bf16 v[208:223], v[252:255], v[132:135], v[208:223]
    ds_read_b64_tr_b16 v[240:241], v22 offset:3584
    ds_read_b64_tr_b16 v[242:243], v22 offset:3712
    ds_read_b64_tr_b16 v[244:245], v22 offset:3840
    ds_read_b64_tr_b16 v[246:247], v22 offset:3968
    v_exp_f32 v147, v147
    v_cvt_pk_bf16_f32 v144, v144, v145
    s_add_u32 m0, m0, 8192
    s_add_u32 s31, s31, 8192
    buffer_load_dwordx4 v5, s[32:35], s31 offen offset:0  lds
    v_exp_f32 v148, v148
    v_pk_fma_f32 v[164:165], v[164:165], s[46:47], v[26:27] op_sel_hi:[1,0,0] neg_lo:[0,0,1] neg_hi:[0,0,1]
    v_exp_f32 v149, v149
    v_cvt_pk_bf16_f32 v145, v146, v147
    v_exp_f32 v150, v150
    v_pk_fma_f32 v[166:167], v[166:167], s[46:47], v[26:27] op_sel_hi:[1,0,0] neg_lo:[0,0,1] neg_hi:[0,0,1]
    v_exp_f32 v151, v151
    v_cvt_pk_bf16_f32 v146, v148, v149
    v_exp_f32 v152, v152
    v_pk_fma_f32 v[168:169], v[168:169], s[46:47], v[26:27] op_sel_hi:[1,0,0] neg_lo:[0,0,1] neg_hi:[0,0,1]
    v_exp_f32 v153, v153
    v_cvt_pk_bf16_f32 v147, v150, v151
    s_add_u32 m0, m0, 8192
    s_add_u32 s31, s31, 8192
    buffer_load_dwordx4 v5, s[32:35], s31 offen offset:0  lds
    v_exp_f32 v154, v154
    v_pk_fma_f32 v[170:171], v[170:171], s[46:47], v[26:27] op_sel_hi:[1,0,0] neg_lo:[0,0,1] neg_hi:[0,0,1]
    v_exp_f32 v155, v155
    v_cvt_pk_bf16_f32 v148, v152, v153
    v_exp_f32 v156, v156
    v_pk_fma_f32 v[172:173], v[172:173], s[46:47], v[26:27] op_sel_hi:[1,0,0] neg_lo:[0,0,1] neg_hi:[0,0,1]
    s_waitcnt lgkmcnt(8)
    v_mfma_f32_32x32x16_bf16 v[208:223], v[224:227], v[144:147], v[208:223]
    v_exp_f32 v157, v157
    v_cvt_pk_bf16_f32 v149, v154, v155
    v_exp_f32 v158, v158
    v_pk_fma_f32 v[174:175], v[174:175], s[46:47], v[26:27] op_sel_hi:[1,0,0] neg_lo:[0,0,1] neg_hi:[0,0,1]
    v_exp_f32 v159, v159
    v_cvt_pk_bf16_f32 v150, v156, v157
    s_nop 0
    v_cvt_pk_bf16_f32 v151, v158, v159
    v_exp_f32 v160, v160
    v_pk_fma_f32 v[176:177], v[176:177], s[46:47], v[26:27] op_sel_hi:[1,0,0] neg_lo:[0,0,1] neg_hi:[0,0,1]
    v_exp_f32 v161, v161
    v_exp_f32 v162, v162
    v_pk_fma_f32 v[178:179], v[178:179], s[46:47], v[26:27] op_sel_hi:[1,0,0] neg_lo:[0,0,1] neg_hi:[0,0,1]
    v_mfma_f32_32x32x16_bf16 v[208:223], v[228:231], v[148:151], v[208:223]
    ds_read_b64_tr_b16 v[248:249], v22 offset:0
    ds_read_b64_tr_b16 v[250:251], v22 offset:128
    ds_read_b64_tr_b16 v[252:253], v22 offset:256
    ds_read_b64_tr_b16 v[254:255], v22 offset:384
    v_exp_f32 v163, v163
    v_cvt_pk_bf16_f32 v160, v160, v161
    s_add_u32 m0, m0, 8192
    s_add_u32 s31, s31, 8192
    buffer_load_dwordx4 v5, s[32:35], s31 offen offset:0  lds
    v_exp_f32 v164, v164
    v_pk_fma_f32 v[180:181], v[180:181], s[46:47], v[26:27] op_sel_hi:[1,0,0] neg_lo:[0,0,1] neg_hi:[0,0,1]
    v_exp_f32 v165, v165
    v_cvt_pk_bf16_f32 v161, v162, v163
    v_exp_f32 v166, v166
    v_pk_fma_f32 v[182:183], v[182:183], s[46:47], v[26:27] op_sel_hi:[1,0,0] neg_lo:[0,0,1] neg_hi:[0,0,1]
    v_exp_f32 v167, v167
    v_cvt_pk_bf16_f32 v162, v164, v165
    v_exp_f32 v168, v168
    v_pk_fma_f32 v[184:185], v[184:185], s[46:47], v[26:27] op_sel_hi:[1,0,0] neg_lo:[0,0,1] neg_hi:[0,0,1]
    v_exp_f32 v169, v169
    v_cvt_pk_bf16_f32 v163, v166, v167
    s_cmp_lt_u32 s26, 2
    s_cselect_b32 s29, 8192, 0
    s_add_u32 m0, m0, s29
    s_add_u32 s31, s31, s29
    buffer_load_dwordx4 v5, s[32:35], s31 offen offset:0  lds
    v_exp_f32 v170, v170
    v_pk_fma_f32 v[186:187], v[186:187], s[46:47], v[26:27] op_sel_hi:[1,0,0] neg_lo:[0,0,1] neg_hi:[0,0,1]
    v_exp_f32 v171, v171
    v_cvt_pk_bf16_f32 v164, v168, v169
    v_exp_f32 v172, v172
    v_pk_fma_f32 v[188:189], v[188:189], s[46:47], v[26:27] op_sel_hi:[1,0,0] neg_lo:[0,0,1] neg_hi:[0,0,1]
    s_waitcnt lgkmcnt(8)
    v_mfma_f32_32x32x16_bf16 v[208:223], v[232:235], v[160:163], v[208:223]
    v_exp_f32 v173, v173
    v_cvt_pk_bf16_f32 v165, v170, v171
    v_exp_f32 v174, v174
    v_pk_fma_f32 v[190:191], v[190:191], s[46:47], v[26:27] op_sel_hi:[1,0,0] neg_lo:[0,0,1] neg_hi:[0,0,1]
    v_exp_f32 v175, v175
    v_cvt_pk_bf16_f32 v166, v172, v173
    s_nop 0
    v_cvt_pk_bf16_f32 v167, v174, v175
    v_exp_f32 v176, v176
    v_pk_fma_f32 v[64:65], v[64:65], s[46:47], v[26:27] op_sel_hi:[1,0,0] neg_lo:[0,0,1] neg_hi:[0,0,1]
    v_exp_f32 v177, v177
    v_exp_f32 v178, v178
    v_pk_fma_f32 v[66:67], v[66:67], s[46:47], v[26:27] op_sel_hi:[1,0,0] neg_lo:[0,0,1] neg_hi:[0,0,1]
    v_mfma_f32_32x32x16_bf16 v[208:223], v[236:239], v[164:167], v[208:223]
    ds_read_b64_tr_b16 v[224:225], v22 offset:4096
    ds_read_b64_tr_b16 v[226:227], v22 offset:4224
    ds_read_b64_tr_b16 v[228:229], v22 offset:4352
    ds_read_b64_tr_b16 v[230:231], v22 offset:4480
    v_exp_f32 v179, v179
    v_cvt_pk_bf16_f32 v176, v176, v177
    v_exp_f32 v180, v180
    v_pk_fma_f32 v[68:69], v[68:69], s[46:47], v[26:27] op_sel_hi:[1,0,0] neg_lo:[0,0,1] neg_hi:[0,0,1]
    v_exp_f32 v181, v181
    v_cvt_pk_bf16_f32 v177, v178, v179
    v_exp_f32 v182, v182
    v_pk_fma_f32 v[70:71], v[70:71], s[46:47], v[26:27] op_sel_hi:[1,0,0] neg_lo:[0,0,1] neg_hi:[0,0,1]
    v_exp_f32 v183, v183
    v_cvt_pk_bf16_f32 v178, v180, v181
    v_exp_f32 v184, v184
    v_pk_fma_f32 v[72:73], v[72:73], s[46:47], v[26:27] op_sel_hi:[1,0,0] neg_lo:[0,0,1] neg_hi:[0,0,1]
    v_exp_f32 v185, v185
    v_cvt_pk_bf16_f32 v179, v182, v183
    v_exp_f32 v186, v186
    v_pk_fma_f32 v[74:75], v[74:75], s[46:47], v[26:27] op_sel_hi:[1,0,0] neg_lo:[0,0,1] neg_hi:[0,0,1]
    v_exp_f32 v187, v187
    v_cvt_pk_bf16_f32 v180, v184, v185
    v_exp_f32 v188, v188
    v_pk_fma_f32 v[76:77], v[76:77], s[46:47], v[26:27] op_sel_hi:[1,0,0] neg_lo:[0,0,1] neg_hi:[0,0,1]
    s_waitcnt lgkmcnt(8)
    v_mfma_f32_32x32x16_bf16 v[208:223], v[240:243], v[176:179], v[208:223]
    v_exp_f32 v189, v189
    v_cvt_pk_bf16_f32 v181, v186, v187
    v_exp_f32 v190, v190
    v_pk_fma_f32 v[78:79], v[78:79], s[46:47], v[26:27] op_sel_hi:[1,0,0] neg_lo:[0,0,1] neg_hi:[0,0,1]
    v_exp_f32 v191, v191
    v_cvt_pk_bf16_f32 v182, v188, v189
    s_nop 0
    v_cvt_pk_bf16_f32 v183, v190, v191
    s_waitcnt vmcnt(0)
    s_barrier
    v_exp_f32 v64, v64
    v_exp_f32 v65, v65
    v_exp_f32 v66, v66
    v_mfma_f32_32x32x16_bf16 v[208:223], v[244:247], v[180:183], v[208:223]
    v_exp_f32 v67, v67
    v_cvt_pk_bf16_f32 v64, v64, v65
    v_exp_f32 v68, v68
    v_bfi_b32 v192, v36, 0, v64
    v_and_b32 v64, v36, v64
    v_exp_f32 v69, v69
    v_cvt_pk_bf16_f32 v65, v66, v67
    v_exp_f32 v70, v70
    v_bfi_b32 v193, v37, 0, v65
    v_and_b32 v65, v37, v65
    v_exp_f32 v71, v71
    v_cvt_pk_bf16_f32 v66, v68, v69
    v_exp_f32 v72, v72
    v_bfi_b32 v194, v38, 0, v66
    v_and_b32 v66, v38, v66
    v_exp_f32 v73, v73
    v_cvt_pk_bf16_f32 v67, v70, v71
    v_exp_f32 v74, v74
    v_bfi_b32 v195, v39, 0, v67
    v_and_b32 v67, v39, v67
    v_exp_f32 v75, v75
    v_cvt_pk_bf16_f32 v68, v72, v73
    v_exp_f32 v76, v76
    v_bfi_b32 v196, v40, 0, v68
    v_and_b32 v68, v40, v68
    s_waitcnt lgkmcnt(4)
    v_mfma_f32_32x32x16_bf16 v[208:223], v[248:251], v[64:67], v[208:223]
    v_exp_f32 v77, v77
    v_cvt_pk_bf16_f32 v69, v74, v75
    v_exp_f32 v78, v78
    v_bfi_b32 v197, v41, 0, v69
    v_and_b32 v69, v41, v69
    v_exp_f32 v79, v79
    v_cvt_pk_bf16_f32 v70, v76, v77
    s_nop 0
    v_cvt_pk_bf16_f32 v71, v78, v79
    v_bfi_b32 v198, v42, 0, v70
    v_and_b32 v70, v42, v70
    v_bfi_b32 v199, v43, 0, v71
    v_and_b32 v71, v43, v71
    s_waitcnt lgkmcnt(0)
    v_mfma_f32_32x32x16_bf16 v[208:223], v[224:227], v[192:195], v[208:223]
    v_mfma_f32_32x32x16_bf16 v[208:223], v[252:255], v[68:71], v[208:223]
    v_mfma_f32_32x32x16_bf16 v[208:223], v[228:231], v[196:199], v[208:223]
    s_mov_b32 s66, s44
    s_mov_b32 s67, s45
    s_nop 4
    v_bfe_u32 v26, v1, 4, 1
    v_and_b32 v27, 15, v1
    v_lshlrev_b32 v27, 4, v27
    v_lshl_add_u32 v27, v26, 10, v27
    v_lshrrev_b32 v26, 5, v1
    v_lshl_add_u32 v28, v26, 8, v27
    v_lshlrev_b32 v27, 2, v1
    v_rcp_f32 v24, v218
    s_nop 0
    v_pk_mul_f32 v[208:209], v[208:209], v[24:25] op_sel_hi:[1,0]
    v_pk_mul_f32 v[210:211], v[210:211], v[24:25] op_sel_hi:[1,0]
    v_pk_mul_f32 v[212:213], v[212:213], v[24:25] op_sel_hi:[1,0]
    v_pk_mul_f32 v[214:215], v[214:215], v[24:25] op_sel_hi:[1,0]
    v_pk_mul_f32 v[216:217], v[216:217], v[24:25] op_sel_hi:[1,0]
    v_cvt_pk_bf16_f32 v208, v208, v209
    v_cvt_pk_bf16_f32 v209, v210, v211
    v_cvt_pk_bf16_f32 v210, v212, v213
    v_cvt_pk_bf16_f32 v211, v214, v215
    v_cvt_pk_bf16_f32 v212, v216, v217
    buffer_store_dwordx4 v[208:211], v28, s[32:35], s66 offen offset:0 sc1
    s_mov_b32 exec_hi, 0
    buffer_store_dword v212, v27, s[32:35], s67 offen offset:0 sc1
    s_mov_b32 exec_hi, -1
    s_mul_i32 s31, s28, 40960
    s_add_u32 s31, s31, 71680
    v_add_u32 v10, s31, v5
    s_lshl_b32 s31, s28, 11
    v_add_u32 v8, s31, v10
    s_xor_b32 s31, s31, 2048
    v_add_u32 v9, s31, v10
    ds_read_b128 v[72:75], v8 offset:0
    ds_read_b128 v[76:79], v8 offset:1024
    ds_read_b128 v[80:83], v9 offset:0
    ds_read_b128 v[84:87], v9 offset:1024
    ds_read_b128 v[88:91], v10 offset:4096
    ds_read_b128 v[92:95], v8 offset:5120
    ds_read_b128 v[96:99], v8 offset:6144
    ds_read_b128 v[100:103], v9 offset:5120
    ds_read_b128 v[104:107], v9 offset:6144
    ds_read_b128 v[108:111], v10 offset:9216
    ds_read_b128 v[112:115], v8 offset:10240
    ds_read_b128 v[116:119], v8 offset:11264
    ds_read_b128 v[120:123], v9 offset:10240
    ds_read_b128 v[124:127], v9 offset:11264
    ds_read_b128 v[128:131], v10 offset:14336
    ds_read_b128 v[132:135], v8 offset:15360
    ds_read_b128 v[136:139], v8 offset:16384
    ds_read_b128 v[140:143], v9 offset:15360
    ds_read_b128 v[144:147], v9 offset:16384
    ds_read_b128 v[148:151], v10 offset:19456
    ds_read_b128 v[152:155], v8 offset:20480
    ds_read_b128 v[156:159], v8 offset:21504
    ds_read_b128 v[160:163], v9 offset:20480
    ds_read_b128 v[164:167], v9 offset:21504
    ds_read_b128 v[168:171], v10 offset:24576
    ds_read_b128 v[172:175], v8 offset:25600
    ds_read_b128 v[176:179], v8 offset:26624
    ds_read_b128 v[180:183], v9 offset:25600
    ds_read_b128 v[184:187], v9 offset:26624
    ds_read_b128 v[188:191], v10 offset:29696
    ds_read_b128 v[192:195], v8 offset:30720
    ds_read_b128 v[196:199], v8 offset:31744
    ds_read_b128 v[200:203], v9 offset:30720
    ds_read_b128 v[204:207], v9 offset:31744
    ds_read_b128 v[208:211], v10 offset:34816
    ds_read_b128 v[212:215], v8 offset:35840
    ds_read_b128 v[216:219], v8 offset:36864
    ds_read_b128 v[220:223], v9 offset:35840
    ds_read_b128 v[224:227], v9 offset:36864
    ds_read_b128 v[228:231], v10 offset:39936
    s_mul_i32 s31, s28, -35840
    s_add_u32 s31, s31, 81920
    v_add_u32 v8, s31, v8
    v_add_u32 v9, s31, v9
    v_add_u32 v10, s31, v10
    ds_read_b128 v[232:235], v8 offset:0
    ds_read_b128 v[236:239], v8 offset:1024
    ds_read_b128 v[240:243], v9 offset:0
    ds_read_b128 v[244:247], v9 offset:1024
    ds_read_b128 v[248:251], v10 offset:4096
    s_waitcnt vmcnt(0)
O_pub:
    s_lshl_b32 s56, s10, 4
    s_add_u32 s57, s56, s24
    s_lshl_b32 s57, s57, 11
    s_add_u32 s57, s57, 0x720000
    s_lshr_b32 s58, s12, 1
    s_add_u32 s58, s58, s56
    s_lshl_b32 s58, s58, 11
    s_add_u32 s59, s58, 0x700000
    s_and_b32 s56, s12, 1
    s_lshl_b32 s56, s56, 3
    s_add_u32 s56, s56, s13
    s_lshl_b32 s56, s56, 7
    s_add_u32 s58, s58, s56
    s_add_u32 s58, s58, 0x720000
    s_waitcnt lgkmcnt(0)
    s_barrier
    s_cmp_lg_u32 s26, 0
    s_cbranch_scc1 arr4
    v_lshlrev_b32 v29, 7, v1
    v_mov_b32 v30, 1
    s_mov_b64 exec, 0xffff
    buffer_atomic_add v30, v29, s[32:35], s57 offen sc1
    s_mov_b64 exec, -1
arr4:
    v_and_b32 v3, 15, v1
    v_lshrrev_b32 v4, 4, v1
    s_lshl_b32 s29, s12, 2
    s_add_u32 s29, s29, s27
    v_and_b32 v6, 1, v4
    v_lshrrev_b32 v7, 1, v4
    v_lshl_add_u32 v6, v6, 1, v7
    v_lshlrev_b32 v6, 8, v6
    v_lshl_add_u32 v6, v3, 4, v6
    v_lshlrev_b32 v7, 4, v3
    v_lshl_add_u32 v7, v4, 3, v7
    s_mul_i32 s60, s29, 18432
    s_mul_i32 s61, s13, 2304
    s_add_u32 s60, s60, s61
    s_mul_i32 s61, s10, 0x240000
    s_add_u32 s60, s60, s61
    s_add_u32 s60, s60, 0x2400000
    s_lshl_b32 s61, s28, 10
    s_add_u32 s61, s61, s60
    buffer_load_dwordx4 v[252:255], v6, s[32:35], s61 offen offset:0
    buffer_load_dwordx2 v[12:13], v7, s[32:35], s60 offen offset:2048
    s_xor_b32 s15, s14, 1
    s_lshr_b32 s30, s29, 1
    s_mul_i32 s30, s30, 36864
    s_mul_i32 s31, s10, 0x240000
    s_add_u32 s30, s30, s31
    s_add_u32 s30, s30, 0x3000000
    s_and_b32 s31, s29, 1
    s_lshl_b32 s62, s31, 6
    s_add_u32 s62, s62, s30
    s_lshl_b32 s31, s31, 10
    s_add_u32 s30, s30, s31
    s_lshl_b32 s31, s28, 11
    s_add_u32 s62, s62, s31
    s_add_u32 s62, s62, 32768
    s_lshl_b32 s31, s28, 14
    s_add_u32 s30, s30, s31
    v_lshlrev_b32 v11, 2, v3
    v_lshl_add_u32 v11, v4, 9, v11
    s_mul_i32 s31, s26, 3072
    s_add_u32 s31, s31, 0
    v_add_u32 v14, s31, v5
    s_xor_b32 s31, s26, 4
    s_mul_i32 s31, s31, 3072
    s_add_u32 s31, s31, 0
    v_add_u32 v15, s31, v5
    s_lshl_b32 s31, s26, 10
    s_add_u32 s31, s31, 0
    s_add_u32 m0, s31, 34816
    s_mul_i32 s56, s25, 129024
    s_add_u32 s31, s31, s56
    s_mul_i32 s56, s15, 0x200000
    s_add_u32 s31, s31, s56
    buffer_load_dwordx4 v5, s[32:35], s31 offen offset:0  lds
    s_add_u32 m0, m0, 8192
    s_add_u32 s31, s31, 8192
    buffer_load_dwordx4 v5, s[32:35], s31 offen offset:0  lds
    s_add_u32 m0, m0, 8192
    s_add_u32 s31, s31, 8192
    buffer_load_dwordx4 v5, s[32:35], s31 offen offset:0  lds
    s_add_u32 m0, m0, 8192
    s_add_u32 s31, s31, 8192
    buffer_load_dwordx4 v5, s[32:35], s31 offen offset:0  lds
    s_add_u32 m0, m0, 8192
    s_add_u32 s31, s31, 8192
    buffer_load_dwordx4 v5, s[32:35], s31 offen offset:0  lds
    s_add_u32 m0, m0, 8192
    s_add_u32 s31, s31, 8192
    buffer_load_dwordx4 v5, s[32:35], s31 offen offset:0  lds
    s_add_u32 m0, m0, 8192
    s_add_u32 s31, s31, 8192
    buffer_load_dwordx4 v5, s[32:35], s31 offen offset:0  lds
    s_add_u32 m0, m0, 8192
    s_add_u32 s31, s31, 8192
    buffer_load_dwordx4 v5, s[32:35], s31 offen offset:0  lds
    s_waitcnt lgkmcnt(0)
    s_cmp_lg_u32 s26, 0
    s_cbranch_scc1 pl5_e
    v_mov_b32 v29, 0
    s_mov_b64 exec, 1
    s_mov_b32 s90, 0
pl5:
    buffer_load_dword v27, v29, s[32:35], s58 offen sc1
    s_waitcnt vmcnt(0)
    v_readfirstlane_b32 s91, v27
    s_add_u32 s90, s90, 1
    s_cmp_ge_u32 s90, 200000
    s_cbranch_scc1 pl5_d
    s_cmp_lt_u32 s91, 16
    s_cbranch_scc1 pl5
pl5_d:
    s_mov_b64 exec, -1
pl5_e:
    s_barrier
    buffer_load_dwordx4 v[36:39], v5, s[32:35], s30 offen offset:0
    buffer_load_dwordx4 v[40:43], v5, s[32:35], s30 offen offset:2048
    s_add_u32 s30, s30, 4096
    buffer_load_dwordx4 v[44:47], v5, s[32:35], s30 offen offset:0
    buffer_load_dwordx4 v[48:51], v5, s[32:35], s30 offen offset:2048
    s_waitcnt vmcnt(3)
    v_mfma_f32_16x16x32_bf16 v[24:27], v[80:83], v[36:39], 0
    s_add_u32 s30, s30, 4096
    buffer_load_dwordx4 v[52:55], v5, s[32:35], s30 offen offset:0
    v_mfma_f32_16x16x32_bf16 v[28:31], v[84:87], v[36:39], 0
    v_mfma_f32_16x16x32_bf16 v[32:35], v[88:91], v[36:39], 0
    v_mfma_f32_16x16x32_bf16 v[16:19], v[72:75], v[36:39], 0
    v_mfma_f32_16x16x32_bf16 v[20:23], v[76:79], v[36:39], 0
    s_waitcnt vmcnt(3)
    v_mfma_f32_16x16x32_bf16 v[24:27], v[100:103], v[40:43], v[24:27]
    buffer_load_dwordx4 v[56:59], v5, s[32:35], s30 offen offset:2048
    v_mfma_f32_16x16x32_bf16 v[28:31], v[104:107], v[40:43], v[28:31]
    v_mfma_f32_16x16x32_bf16 v[32:35], v[108:111], v[40:43], v[32:35]
    v_mfma_f32_16x16x32_bf16 v[16:19], v[92:95], v[40:43], v[16:19]
    v_mfma_f32_16x16x32_bf16 v[20:23], v[96:99], v[40:43], v[20:23]
    s_waitcnt vmcnt(3)
    v_mfma_f32_16x16x32_bf16 v[24:27], v[120:123], v[44:47], v[24:27]
    s_add_u32 s30, s30, 4096
    buffer_load_dwordx4 v[60:63], v5, s[32:35], s30 offen offset:0
    v_mfma_f32_16x16x32_bf16 v[28:31], v[124:127], v[44:47], v[28:31]
    v_mfma_f32_16x16x32_bf16 v[32:35], v[128:131], v[44:47], v[32:35]
    v_mfma_f32_16x16x32_bf16 v[16:19], v[112:115], v[44:47], v[16:19]
    v_mfma_f32_16x16x32_bf16 v[20:23], v[116:119], v[44:47], v[20:23]
    s_waitcnt vmcnt(3)
    v_mfma_f32_16x16x32_bf16 v[24:27], v[140:143], v[48:51], v[24:27]
    buffer_load_dwordx4 v[64:67], v5, s[32:35], s30 offen offset:2048
    v_mfma_f32_16x16x32_bf16 v[28:31], v[144:147], v[48:51], v[28:31]
    v_mfma_f32_16x16x32_bf16 v[32:35], v[148:151], v[48:51], v[32:35]
    v_mfma_f32_16x16x32_bf16 v[16:19], v[132:135], v[48:51], v[16:19]
    v_mfma_f32_16x16x32_bf16 v[20:23], v[136:139], v[48:51], v[20:23]
    s_waitcnt vmcnt(3)
    v_mfma_f32_16x16x32_bf16 v[24:27], v[160:163], v[52:55], v[24:27]
    buffer_load_dword v68, v11, s[32:35], s62 offen offset:0
    buffer_load_dword v69, v11, s[32:35], s62 offen offset:128
    buffer_load_dword v70, v11, s[32:35], s62 offen offset:256
    buffer_load_dword v71, v11, s[32:35], s62 offen offset:384
    v_mfma_f32_16x16x32_bf16 v[28:31], v[164:167], v[52:55], v[28:31]
    v_mfma_f32_16x16x32_bf16 v[32:35], v[168:171], v[52:55], v[32:35]
    v_mfma_f32_16x16x32_bf16 v[16:19], v[152:155], v[52:55], v[16:19]
    v_mfma_f32_16x16x32_bf16 v[20:23], v[156:159], v[52:55], v[20:23]
    s_waitcnt vmcnt(6)
    v_mfma_f32_16x16x32_bf16 v[24:27], v[180:183], v[56:59], v[24:27]
    v_mfma_f32_16x16x32_bf16 v[28:31], v[184:187], v[56:59], v[28:31]
    v_mfma_f32_16x16x32_bf16 v[32:35], v[188:191], v[56:59], v[32:35]
    v_mfma_f32_16x16x32_bf16 v[16:19], v[172:175], v[56:59], v[16:19]
    v_mfma_f32_16x16x32_bf16 v[20:23], v[176:179], v[56:59], v[20:23]
    s_waitcnt vmcnt(5)
    v_mfma_f32_16x16x32_bf16 v[24:27], v[200:203], v[60:63], v[24:27]
    v_mfma_f32_16x16x32_bf16 v[28:31], v[204:207], v[60:63], v[28:31]
    v_mfma_f32_16x16x32_bf16 v[32:35], v[208:211], v[60:63], v[32:35]
    v_mfma_f32_16x16x32_bf16 v[16:19], v[192:195], v[60:63], v[16:19]
    v_mfma_f32_16x16x32_bf16 v[20:23], v[196:199], v[60:63], v[20:23]
    s_waitcnt vmcnt(4)
    v_mfma_f32_16x16x32_bf16 v[24:27], v[220:223], v[64:67], v[24:27]
    v_mfma_f32_16x16x32_bf16 v[28:31], v[224:227], v[64:67], v[28:31]
    v_mfma_f32_16x16x32_bf16 v[32:35], v[228:231], v[64:67], v[32:35]
    v_mfma_f32_16x16x32_bf16 v[16:19], v[212:215], v[64:67], v[16:19]
    v_mfma_f32_16x16x32_bf16 v[20:23], v[216:219], v[64:67], v[20:23]
    s_waitcnt vmcnt(0)
    v_mfma_f32_16x16x32_bf16 v[24:27], v[240:243], v[68:71], v[24:27]
    v_mfma_f32_16x16x32_bf16 v[28:31], v[244:247], v[68:71], v[28:31]
    v_mfma_f32_16x16x32_bf16 v[32:35], v[248:251], v[68:71], v[32:35]
    v_mfma_f32_16x16x32_bf16 v[16:19], v[232:235], v[68:71], v[16:19]
    v_mfma_f32_16x16x32_bf16 v[20:23], v[236:239], v[68:71], v[20:23]
    s_nop 0
    v_lshlrev_b32 v40, 16, v252
    v_and_b32 v41, 0xffff0000, v252
    v_lshlrev_b32 v42, 16, v253
    v_and_b32 v43, 0xffff0000, v253
    v_lshlrev_b32 v44, 16, v254
    v_and_b32 v45, 0xffff0000, v254
    v_lshlrev_b32 v46, 16, v255
    v_and_b32 v47, 0xffff0000, v255
    ds_write_b128 v14, v[24:27] offset:0
    ds_write_b128 v14, v[28:31] offset:1024
    ds_write_b128 v14, v[32:35] offset:2048
    v_lshlrev_b32 v48, 16, v12
    v_and_b32 v49, 0xffff0000, v12
    v_lshlrev_b32 v50, 16, v13
    v_and_b32 v51, 0xffff0000, v13
    s_add_u32 s60, s60, 0x240000
    s_add_u32 s61, s61, 0x240000
    s_waitcnt lgkmcnt(0)
    s_barrier
    ds_read_b128 v[64:67], v15 offset:0
    ds_read_b128 v[68:71], v15 offset:1024
    ds_read_b128 v[72:75], v15 offset:2048
    s_waitcnt lgkmcnt(1)
    v_pk_add_f32 v[16:17], v[16:17], v[64:65]
    v_pk_add_f32 v[18:19], v[18:19], v[66:67]
    v_pk_add_f32 v[20:21], v[20:21], v[68:69]
    v_pk_add_f32 v[22:23], v[22:23], v[70:71]
    v_cvt_pk_bf16_f32 v80, v16, v17
    v_cvt_pk_bf16_f32 v81, v18, v19
    v_cvt_pk_bf16_f32 v82, v20, v21
    v_cvt_pk_bf16_f32 v83, v22, v23
    s_waitcnt lgkmcnt(0)
    v_pk_add_f32 v[32:33], v[32:33], v[72:73]
    v_permlane16_swap_b32 v80, v82
    v_permlane16_swap_b32 v81, v83
    v_pk_add_f32 v[34:35], v[34:35], v[74:75]
    v_lshlrev_b32 v84, 16, v80
    v_and_b32 v85, 0xffff0000, v80
    v_lshlrev_b32 v86, 16, v81
    v_and_b32 v87, 0xffff0000, v81
    v_lshlrev_b32 v88, 16, v82
    v_and_b32 v89, 0xffff0000, v82
    v_lshlrev_b32 v90, 16, v83
    v_and_b32 v91, 0xffff0000, v83
    v_cvt_pk_bf16_f32 v92, v32, v33
    v_cvt_pk_bf16_f32 v93, v34, v35
    v_pk_add_f32 v[40:41], v[40:41], v[84:85]
    v_pk_add_f32 v[42:43], v[42:43], v[86:87]
    v_pk_add_f32 v[44:45], v[44:45], v[88:89]
    v_pk_add_f32 v[46:47], v[46:47], v[90:91]
    v_lshlrev_b32 v94, 16, v92
    v_and_b32 v95, 0xffff0000, v92
    v_lshlrev_b32 v96, 16, v93
    v_and_b32 v97, 0xffff0000, v93
    v_cvt_pk_bf16_f32 v24, v40, v41
    v_cvt_pk_bf16_f32 v25, v42, v43
    v_cvt_pk_bf16_f32 v26, v44, v45
    v_cvt_pk_bf16_f32 v27, v46, v47
    v_pk_add_f32 v[48:49], v[48:49], v[94:95]
    v_pk_add_f32 v[50:51], v[50:51], v[96:97]
    v_cvt_pk_bf16_f32 v52, v48, v49
    v_cvt_pk_bf16_f32 v53, v50, v51
    v_mov_b32 v54, v52
    v_mov_b32 v55, v53
    v_lshlrev_b32 v7, 4, v3
    s_nop 0
    v_permlane16_swap_b32 v52, v54
    v_permlane16_swap_b32 v53, v55
    s_cmp_eq_u32 s10, 3
    s_cbranch_scc1 W_final
    s_mov_b32 s16, s17
    s_cmp_eq_u32 s28, 0
    s_cselect_b32 s56, -1, 0
    buffer_store_dwordx4 v[24:27], v6, s[32:35], s61 offen offset:0 sc1
    s_cmp_eq_u32 s28, 0
    s_cbranch_scc0 xs6
    s_mov_b64 exec, 0xffff
    buffer_store_dwordx4 v[52:55], v7, s[32:35], s60 offen offset:2048 sc1
    s_mov_b64 exec, -1
xs6:
W_pub:
    s_lshl_b32 s31, s26, 10
    s_add_u32 s31, s31, 65536
    s_add_u32 m0, s31, 34816
    s_mul_i32 s56, s25, 129024
    s_add_u32 s31, s31, s56
    s_mul_i32 s56, s15, 0x200000
    s_add_u32 s31, s31, s56
    buffer_load_dwordx4 v5, s[32:35], s31 offen offset:0  lds
    s_add_u32 m0, m0, 8192
    s_add_u32 s31, s31, 8192
    buffer_load_dwordx4 v5, s[32:35], s31 offen offset:0  lds
    s_add_u32 m0, m0, 8192
    s_add_u32 s31, s31, 8192
    buffer_load_dwordx4 v5, s[32:35], s31 offen offset:0  lds
    s_add_u32 m0, m0, 8192
    s_add_u32 s31, s31, 8192
    buffer_load_dwordx4 v5, s[32:35], s31 offen offset:0  lds
    s_add_u32 m0, m0, 8192
    s_add_u32 s31, s31, 8192
    buffer_load_dwordx4 v5, s[32:35], s31 offen offset:0  lds
    s_add_u32 m0, m0, 8192
    s_add_u32 s31, s31, 8192
    buffer_load_dwordx4 v5, s[32:35], s31 offen offset:0  lds
    s_add_u32 m0, m0, 8192
    s_add_u32 s31, s31, 8192
    buffer_load_dwordx4 v5, s[32:35], s31 offen offset:0  lds
    s_add_u32 m0, m0, 8192
    s_add_u32 s31, s31, 8192
    s_cmp_ge_u32 s26, 6
    s_cselect_b32 s56, 8192, 0
    s_sub_u32 m0, m0, s56
    s_sub_u32 s31, s31, s56
    buffer_load_dwordx4 v5, s[32:35], s31 offen offset:0  lds
    s_waitcnt vmcnt(8)
    s_barrier
    s_and_b32 s65, s12, 1
    s_lshl_b32 s65, s65, 3
    s_add_u32 s65, s65, s13
    s_cmp_lg_u32 s26, 0
    s_cbranch_scc1 arr7
    v_lshlrev_b32 v29, 7, v1
    v_mov_b32 v30, 1
    s_mov_b64 exec, 0xffff
    buffer_atomic_add v30, v29, s[32:35], s59 offen sc1
    s_mov_b64 exec, -1
arr7:
    s_add_u32 s10, s10, 1
    s_branch L_top
W_final:
    v_mul_u32_u24 v8, 1152, v3
    v_lshrrev_b32 v9, 8, v6
    v_lshl_add_u32 v9, v9, 4, v8
    s_mul_i32 s60, s29, 18432
    s_mul_i32 s61, s13, 144
    s_add_u32 s60, s60, s61
    s_lshl_b32 s61, s28, 6
    s_add_u32 s61, s61, s60
    buffer_store_dwordx4 v[24:27], v9, s[36:39], s61 offen
    s_cmp_eq_u32 s28, 0
    s_cbranch_scc0 W_done
    s_mov_b64 exec, 0xffff
    buffer_store_dwordx4 v[52:55], v8, s[36:39], s60 offen offset:128
    s_mov_b64 exec, -1
W_done:
mega_end:
    s_endpgm
code_end:
    s_endpgm
.section .rodata,"a"
.p2align 6
.amdhsa_kernel prep_kernel
  .amdhsa_next_free_vgpr 96
  .amdhsa_next_free_sgpr 96
  .amdhsa_accum_offset 96
  .amdhsa_group_segment_fixed_size 0
  .amdhsa_kernarg_size 80
  .amdhsa_user_sgpr_count 2
  .amdhsa_user_sgpr_kernarg_segment_ptr 1
  .amdhsa_system_sgpr_workgroup_id_x 1
.end_amdhsa_kernel

.p2align 6
.amdhsa_kernel mega_kernel
  .amdhsa_next_free_vgpr 256
  .amdhsa_next_free_sgpr 100
  .amdhsa_accum_offset 256
  .amdhsa_group_segment_fixed_size 0
  .amdhsa_kernarg_size 80
  .amdhsa_user_sgpr_count 2
  .amdhsa_user_sgpr_kernarg_segment_ptr 1
  .amdhsa_system_sgpr_workgroup_id_x 1
.end_amdhsa_kernel
```
